```python
import torch

def _softmax(x, axis=-1):
    return torch.softmax(x, dim=axis)
def _gelu(x):
    return torch.nn.functional.gelu(x, approximate="tanh")
def _silu(x):
    return torch.nn.functional.silu(x)
def _sigmoid(x):
    return torch.sigmoid(x)
def _layernorm(x, axis=-1, eps=1e-5):
    m = x.mean(dim=axis, keepdim=True)
    v = x.var(dim=axis, keepdim=True, unbiased=False)
    return (x - m) / torch.sqrt(v + eps)
def _scatter_add(tgt, idx, src, axis=0):
    return tgt.clone().index_add_(axis, idx, src)
def _segment_sum(src, seg, n):
    out = torch.zeros((n,) + src.shape[1:], dtype=src.dtype)
    return out.index_add_(0, seg, src)
def _pad(x, pw):
    flat = tuple(v for pair in reversed(pw) for v in pair)
    return torch.nn.functional.pad(x, flat)

kernel_name = 'concat_heads__ssm_conv_h3__mha_block__prompt'

def setup_inputs():

    _w = (lambda a: (lambda t: t.to(torch.bfloat16) if t.is_floating_point() else t)(torch.as_tensor(a)))
    def _A_setup():
        B, S, D = 1, 2048, 1024
        ks = 4
        return {
            "q": _w((lambda *s: torch.randn(*s, dtype=torch.bfloat16) * 0.05)(B, S, D)),
            "k": _w((lambda *s: torch.randn(*s, dtype=torch.bfloat16) * 0.8)(B, S, D)),
            "v": _w((lambda *s: torch.randn(*s, dtype=torch.bfloat16) * 0.8)(B, S, D)),
            "shift_k": _w((lambda *s: torch.randn(*s, dtype=torch.bfloat16) * 0.8)(D, ks) * 0.5),
            "ssm_k": _w((lambda *s: torch.randn(*s, dtype=torch.bfloat16) * 0.8)(D, S) * (1.0 / S ** 0.5)),
            "ssm_D": _w((lambda *s: torch.randn(*s, dtype=torch.bfloat16) * 0.8)(D)),
        }
    _A_in = _A_setup()

    def _B_setup():
        B, S, D, H = 1, 2048, 1024, 32
        return {
            "x": _w((lambda *s: torch.randn(*s, dtype=torch.bfloat16) * 0.2)(B, S, D)),
            "wqkv": _w((lambda *s: torch.randn(*s, dtype=torch.bfloat16) * 0.2)(D, 3 * D)),
            "wo": _w((lambda *s: torch.randn(*s, dtype=torch.bfloat16) * 0.05)(D, D)),
        }
    _B_in = _B_setup()

    return {
        "A_q": _A_in["q"],
        "A_k": _A_in["k"],
        "A_v": _A_in["v"],
        "A_shift_k": _A_in["shift_k"],
        "A_ssm_k": _A_in["ssm_k"],
        "A_ssm_D": _A_in["ssm_D"],
        "B_x": _B_in["x"],
        "B_wqkv": _B_in["wqkv"],
        "B_wo": _B_in["wo"],
    }

def reference(A_q, A_k, A_v, A_shift_k, A_ssm_k, A_ssm_D, B_x, B_wqkv, B_wo):
    def _A_ref(q, k, v, shift_k, ssm_k, ssm_D):
        B, S, D = q.shape
        ks = shift_k.shape[-1]
        k_pad = _pad(k, ((0, 0), (ks - 1, 0), (0, 0)))
        k_shift = torch.zeros_like(k)
        for t in range(ks):
            k_shift = k_shift + k_pad[:, t:t + S, :] * shift_k[:, ks - 1 - t][None, None, :]
        kv = k_shift * v
        L = 2 * S
        kv_pad = _pad(kv, ((0, 0), (0, S), (0, 0)))
        kf_pad = _pad(ssm_k, ((0, 0), (0, S)))
        kv_f = (lambda x, axes=(-2,-1): torch.fft.rfft2(x.float(), dim=axes))(kv_pad[:, None, :, :], axes=(1, 2))
        kf_f = (lambda x, axes=(-2,-1): torch.fft.rfft2(x.float(), dim=axes))(kf_pad[:, None, :], axes=(1, 2))
        kf_f = (lambda x, *d: x.permute(*d))(kf_f, 1, 2, 0)
        y_f = kv_f * kf_f[None, :, :, :]
        y = (lambda x, s, axes=(-2,-1): torch.fft.irfft2(x, s=s, dim=axes).to(torch.bfloat16))(y_f, (1, L), axes=(1, 2))[:, 0, :S, :]
        y = y + kv * ssm_D[None, None, :]
        return q * y

    def _B_ref(x, wqkv, wo):
        B, S, D = x.shape
        H = 32
        Dh = D // H
        qkv = (lambda x, *d: x.permute(*d))((x @ wqkv).reshape(B, S, 3, H, Dh), 2, 0, 3, 1, 4)
        q, k, v = qkv[0], qkv[1], qkv[2]
        scores = torch.einsum("bhqd,bhkd->bhqk", q, k) * (Dh ** -0.5)
        p = _softmax(scores, axis=-1)
        o = torch.einsum("bhqk,bhkd->bhqd", p, v)
        return (lambda x, *d: x.permute(*d))(o, 0, 2, 1, 3).reshape(B, S, D) @ wo

    a = _A_ref(A_q, A_k, A_v, A_shift_k, A_ssm_k, A_ssm_D)
    b = _B_ref(B_x, B_wqkv, B_wo)
    return torch.concatenate([a, b], axis=-1)
```

```asm
; @launch kernel=concat_heads__ssm_conv_h3__mha_block__prompt_kernel grid=(256,1,1) block=(832,1,1) lds=161024
.amdgcn_target "amdgcn-amd-amdhsa--gfx950"
.text
.globl concat_heads__ssm_conv_h3__mha_block__prompt_kernel
.p2align 8
.type concat_heads__ssm_conv_h3__mha_block__prompt_kernel,@function
concat_heads__ssm_conv_h3__mha_block__prompt_kernel:
    s_cmp_ge_u32 s2, 256
    s_cbranch_scc1 L_END
    s_load_dwordx4 s[4:7], s[0:1], 48
    s_load_dwordx2 s[98:99], s[0:1], 88
    s_memrealtime s[96:97]
    v_lshrrev_b32 v1, 6, v0
    v_and_b32 v0, 63, v0
    s_and_b32 s8, s2, 7
    v_readfirstlane_b32 s3, v1
    s_lshr_b32 s9, s2, 3
    s_mov_b32 s100, 0x100000
    s_and_b32 s26, s9, 15
    s_lshl_b32 s27, s8, 1
    s_lshr_b32 s10, s9, 4
    s_add_u32 s27, s27, s10
    s_cmp_ge_u32 s3, 4
    s_cbranch_scc1 L_NOTLOADER
    s_and_b32 s34, s3, 2
    s_and_b32 s25, s3, 1
    v_lshrrev_b32 v2, 3, v0
    v_lshlrev_b32 v2, 11, v2
    v_lshrrev_b32 v3, 4, v0
    v_and_b32 v4, 7, v0
    v_xor_b32 v4, v4, v3
    v_lshl_add_u32 v2, v4, 4, v2
    s_lshl_b32 s10, s34, 16
    v_add_u32 v10, s10, v2
    v_xor_b32 v11, 64, v10
    v_add_u32 v12, 30720, v10
    v_add_u32 v13, 46080, v11
    v_add_u32 v11, 15360, v11
    s_lshl_b32 s23, s34, 12
    s_lshl_b32 s10, s25, 14
    s_add_u32 s23, s23, s10
    s_mul_i32 s39, s8, 0
    s_and_b32 s36, s27, 1
    s_mul_i32 s36, s36, 0
    s_add_u32 s39, s39, s36
    s_add_u32 s36, s39, s25
    s_and_b32 s36, s36, 15
    s_lshl_b32 s20, s36, 7
    s_lshl_b32 s10, s26, 18
    s_mov_b32 s14, 262144
    s_mov_b32 s15, 0x20000
    v_bfe_u32 v2, v0, 2, 2
    s_lshl_b32 s29, s26, 2
    v_add_u32 v2, s29, v2
    v_mul_u32_u24 v2, 6144, v2
    v_and_b32 v3, 3, v0
    v_min_u32 v3, 2, v3
    v_lshl_add_u32 v2, v3, 11, v2
    s_lshl_b32 s29, s27, 7
    v_add_u32 v16, s29, v2
    s_add_u32 s35, s39, s3
    s_and_b32 s35, s35, 15
    s_mul_i32 s35, s35, 393216
    s_waitcnt lgkmcnt(0)
    s_mov_b32 s40, s6
    s_mov_b32 s41, s7
    s_mov_b32 s42, 6291456
    s_mov_b32 s43, 0x20000
    buffer_load_dword v17, v16, s[40:43], s35 offen
    s_add_u32 s12, s4, s10
    s_addc_u32 s13, s5, 0
    s_add_u32 m0, s23, 0
    s_add_u32 s10, s20, 0
    buffer_load_dwordx4 v10, s[12:15], s10 offen offset:0 lds
    buffer_load_dwordx4 v11, s[12:15], s10 offen offset:1024 lds
    buffer_load_dwordx4 v12, s[12:15], s10 offen offset:2048 lds
    buffer_load_dwordx4 v13, s[12:15], s10 offen offset:3072 lds
    s_add_u32 m0, s23, 4096
    s_add_u32 s10, s20, 65536
    buffer_load_dwordx4 v10, s[12:15], s10 offen offset:0 lds
    buffer_load_dwordx4 v11, s[12:15], s10 offen offset:1024 lds
    buffer_load_dwordx4 v12, s[12:15], s10 offen offset:2048 lds
    buffer_load_dwordx4 v13, s[12:15], s10 offen offset:3072 lds
    s_add_u32 s20, s20, 256
    s_and_b32 s20, s20, 2047
    s_add_u32 s23, s23, 32768
    s_cmp_ge_u32 s23, 81920
    s_cselect_b32 s10, 81920, 0
    s_sub_u32 s23, s23, s10
    v_lshrrev_b32 v2, 5, v0
    v_lshlrev_b32 v2, 2, v2
    v_bfe_u32 v4, v0, 2, 2
    s_lshl_b32 s10, s34, 4
    v_add3_u32 v2, v2, v4, s10
    v_mul_u32_u24 v2, 6144, v2
    v_bfe_u32 v3, v0, 4, 1
    v_lshl_add_u32 v2, v3, 6, v2
    v_and_b32 v4, 3, v0
    v_lshl_add_u32 v14, v4, 4, v2
    v_add_u32 v15, 48128, v14
    v_lshlrev_b32 v4, 2, v4
    v_add_u32 v18, 160768, v4
    s_mul_i32 s24, s34, 6144
    s_mul_i32 s10, s25, 24576
    s_add_u32 s24, s24, s10
    s_add_u32 s24, s24, 81920
    s_mul_i32 s21, s36, 393216
    s_lshl_b32 s11, s27, 7
    s_sub_u32 s18, 6291456, s11
    s_mov_b32 s19, 0x20000
    s_add_u32 s16, s6, s11
    s_addc_u32 s17, s7, 0
    s_lshl_b64 s[32:33], 1, s3
    s_mov_b32 s37, 393216
    s_cmp_lg_u32 s3, 0
    s_cbranch_scc1 P1_NX
    s_and_b32 s29, s27, 1
    s_lshl_b32 s29, s29, 6
    s_lshl_b32 s10, s26, 7
    s_add_u32 s29, s29, s10
    v_add_u32 v1, s29, v0
    v_lshlrev_b32 v16, 11, v1
    s_mov_b32 s40, s4
    s_mov_b32 s41, s5
    s_mov_b32 s42, 4194304
    s_mov_b32 s43, 0x20000
    s_mov_b32 s37, 128
P1_NX:
    s_cmp_lg_u32 s25, 0
    s_cselect_b32 s42, 0, s42
P1_LISSUE:
    s_add_u32 m0, s24, 0
    s_add_u32 s10, s21, 0
    buffer_load_dwordx4 v14, s[16:19], s10 offen offset:0 lds
    buffer_load_dwordx4 v15, s[16:19], s10 offen offset:1024 lds
    buffer_load_dwordx4 v14, s[16:19], s10 offen offset:2048 lds
    buffer_load_dwordx4 v15, s[16:19], s10 offen offset:3072 lds
    s_add_u32 m0, s24, 4096
    s_add_u32 s10, s21, 4096
    buffer_load_dwordx4 v14, s[16:19], s10 offen offset:0 lds
    buffer_load_dwordx4 v15, s[16:19], s10 offen offset:1024 lds
    s_add_u32 m0, s24, 6144
    s_add_u32 s10, s21, 98304
    buffer_load_dwordx4 v14, s[16:19], s10 offen offset:0 lds
    buffer_load_dwordx4 v15, s[16:19], s10 offen offset:1024 lds
    buffer_load_dwordx4 v14, s[16:19], s10 offen offset:2048 lds
    buffer_load_dwordx4 v15, s[16:19], s10 offen offset:3072 lds
    s_add_u32 m0, s24, 10240
    s_add_u32 s10, s21, 102400
    buffer_load_dwordx4 v14, s[16:19], s10 offen offset:0 lds
    buffer_load_dwordx4 v15, s[16:19], s10 offen offset:1024 lds
    s_add_u32 s36, s36, 2
    s_and_b32 s36, s36, 15
    s_mul_i32 s21, s36, 393216
    s_add_u32 s35, s36, 2
    s_and_b32 s35, s35, 15
    s_mul_i32 s35, s35, s37
    s_cmp_ge_u32 s25, 12
    s_cselect_b32 s42, 0, s42
    s_add_u32 s24, s24, 49152
    s_cmp_ge_u32 s24, 155648
    s_cselect_b32 s11, 73728, 0
    s_sub_u32 s24, s24, s11
    s_add_u32 s25, s25, 2
    s_cmp_ge_u32 s25, 16
    s_cbranch_scc1 P1_LLAST
    s_add_u32 m0, s23, 0
    s_add_u32 s10, s20, 0
    buffer_load_dwordx4 v10, s[12:15], s10 offen offset:0 lds
    buffer_load_dwordx4 v11, s[12:15], s10 offen offset:1024 lds
    buffer_load_dwordx4 v12, s[12:15], s10 offen offset:2048 lds
    buffer_load_dwordx4 v13, s[12:15], s10 offen offset:3072 lds
    s_add_u32 m0, s23, 4096
    s_add_u32 s10, s20, 65536
    buffer_load_dwordx4 v10, s[12:15], s10 offen offset:0 lds
    buffer_load_dwordx4 v11, s[12:15], s10 offen offset:1024 lds
    buffer_load_dwordx4 v12, s[12:15], s10 offen offset:2048 lds
    buffer_load_dwordx4 v13, s[12:15], s10 offen offset:3072 lds
    s_add_u32 s20, s20, 256
    s_and_b32 s20, s20, 2047
    s_add_u32 s23, s23, 32768
    s_cmp_ge_u32 s23, 81920
    s_cselect_b32 s10, 81920, 0
    s_sub_u32 s23, s23, s10
    buffer_load_dword v17, v16, s[40:43], s35 offen
    s_add_u32 s35, s35, s37
    buffer_load_dword v17, v16, s[40:43], s35 offen
    s_cmp_eq_u32 s25, 2
    s_cbranch_scc1 P1_LNB
    s_barrier
P1_LNB:
    s_waitcnt vmcnt(10)
    s_barrier
    s_branch P1_LISSUE
P1_LLAST:
    s_barrier
    s_waitcnt vmcnt(0)
    s_barrier
    s_cmp_lg_u32 s25, 16
    s_cbranch_scc1 P1_LDONE
    s_barrier
P1_LDONE:
    s_lshl_b32 s28, s26, 2
    s_add_u32 s28, s28, s3
    v_lshlrev_b32 v1, 4, v0
    v_mov_b32 v125, 160768
    s_mov_b32 s12, s98
    s_mov_b32 s13, s99
    s_mov_b32 s14, 67108864
    s_mov_b32 s15, 0x20000
    s_lshl_b32 s10, s3, 11
    s_add_u32 s10, s10, 122880
    v_add_u32 v92, s10, v1
    s_branch A_INIT
L_NOTLOADER:
    s_cmp_ge_u32 s3, 8
    s_cbranch_scc1 L_HELPERS
    s_sub_u32 s31, s3, 4
    s_lshr_b32 s28, s31, 1
    s_and_b32 s29, s31, 1
    v_and_b32 v1, 31, v0
    v_lshrrev_b32 v2, 5, v0
    v_bfe_u32 v3, v0, 1, 3
    v_xor_b32 v3, v3, v2
    v_lshlrev_b32 v3, 4, v3
    v_lshl_add_u32 v3, v1, 7, v3
    s_lshl_b32 s10, s28, 13
    v_add_u32 v28, s10, v3
    v_lshlrev_b32 v2, 10, v2
    v_bfe_u32 v3, v0, 2, 2
    v_lshl_add_u32 v2, v3, 6, v2
    v_bfe_u32 v3, v0, 4, 1
    v_lshl_add_u32 v2, v3, 5, v2
    v_and_b32 v3, 3, v0
    v_lshl_add_u32 v2, v3, 3, v2
    s_lshl_b32 s10, s29, 8
    s_add_u32 s10, s10, 81920
    v_add_u32 v29, s10, v2
    v_lshlrev_b32 v3, 2, v3
    v_add_u32 v30, 160768, v3
    v_lshlrev_b32 v3, 2, v0
    v_add_u32 v3, 160768, v3
    v_mov_b32 v31, 0
    ds_write_b32 v3, v31
    v_mov_b32 v8, 0
    v_mov_b32 v9, 0
    v_mov_b32 v10, 0
    v_mov_b32 v11, 0
    v_mov_b32 v12, 0
    v_mov_b32 v13, 0
    v_mov_b32 v14, 0
    v_mov_b32 v15, 0
    v_mov_b32 v16, 0
    v_mov_b32 v17, 0
    v_mov_b32 v18, 0
    v_mov_b32 v19, 0
    v_mov_b32 v20, 0
    v_mov_b32 v21, 0
    v_mov_b32 v22, 0
    v_mov_b32 v23, 0
    v_mov_b32 v24, 0
    v_mov_b32 v25, 0
    v_mov_b32 v26, 0
    v_mov_b32 v27, 0
    v_mov_b32 v32, 0
    v_mov_b32 v33, 0
    v_mov_b32 v34, 0
    v_mov_b32 v35, 0
    v_mov_b32 v36, 0
    v_mov_b32 v37, 0
    v_mov_b32 v38, 0
    v_mov_b32 v39, 0
    v_mov_b32 v40, 0
    v_mov_b32 v41, 0
    v_mov_b32 v42, 0
    v_mov_b32 v43, 0
    v_mov_b32 v44, 0
    v_mov_b32 v45, 0
    v_mov_b32 v46, 0
    v_mov_b32 v47, 0
    v_mov_b32 v48, 0
    v_mov_b32 v49, 0
    v_mov_b32 v50, 0
    v_mov_b32 v51, 0
    v_mov_b32 v52, 0
    v_mov_b32 v53, 0
    v_mov_b32 v54, 0
    v_mov_b32 v55, 0
    v_mov_b32 v56, 0
    v_mov_b32 v57, 0
    v_mov_b32 v58, 0
    v_mov_b32 v59, 0
    v_mov_b32 v60, 0
    v_mov_b32 v61, 0
    v_mov_b32 v62, 0
    v_mov_b32 v63, 0
    v_mov_b32 v64, 0
    v_mov_b32 v65, 0
    v_mov_b32 v66, 0
    v_mov_b32 v67, 0
    v_mov_b32 v68, 0
    v_mov_b32 v69, 0
    v_mov_b32 v70, 0
    v_mov_b32 v71, 0
    v_mov_b32 v72, 0
    v_mov_b32 v73, 0
    v_mov_b32 v74, 0
    v_mov_b32 v75, 0
    v_mov_b32 v76, 0
    v_mov_b32 v77, 0
    v_mov_b32 v78, 0
    v_mov_b32 v79, 0
    v_mov_b32 v80, 0
    v_mov_b32 v81, 0
    v_mov_b32 v82, 0
    v_mov_b32 v83, 0
    v_mov_b32 v84, 0
    v_mov_b32 v85, 0
    v_mov_b32 v86, 0
    v_mov_b32 v87, 0
    v_mov_b32 v88, 0
    v_mov_b32 v89, 0
    v_mov_b32 v90, 0
    v_mov_b32 v91, 0
    v_mov_b32 v92, 0
    v_mov_b32 v93, 0
    v_mov_b32 v94, 0
    v_mov_b32 v95, 0
    v_mov_b32 v96, 0
    v_mov_b32 v97, 0
    v_mov_b32 v98, 0
    v_mov_b32 v99, 0
    v_mov_b32 v100, 0
    v_mov_b32 v101, 0
    v_mov_b32 v102, 0
    v_mov_b32 v103, 0
    v_mov_b32 v104, 0
    v_mov_b32 v105, 0
    v_mov_b32 v106, 0
    v_mov_b32 v107, 0
    v_mov_b32 v108, 0
    v_mov_b32 v109, 0
    v_mov_b32 v110, 0
    v_mov_b32 v111, 0
    v_mov_b32 v112, 0
    v_mov_b32 v113, 0
    v_mov_b32 v114, 0
    v_mov_b32 v115, 0
    v_mov_b32 v116, 0
    v_mov_b32 v117, 0
    v_mov_b32 v118, 0
    v_mov_b32 v119, 0
    v_mov_b32 v120, 0
    v_mov_b32 v121, 0
    v_mov_b32 v122, 0
    v_mov_b32 v123, 0
    v_mov_b32 v124, 0
    v_mov_b32 v125, 0
    v_mov_b32 v126, 0
    v_mov_b32 v127, 0
    s_mov_b32 s25, 0
    s_mov_b32 s24, 0
    s_mov_b32 s21, 0
    s_setprio 3
P1_CLOOP:
    s_waitcnt lgkmcnt(4)
    v_mfma_f32_32x32x16_bf16 v[32:47], v[16:19], v[8:11], v[32:47]
    v_mfma_f32_32x32x16_bf16 v[80:95], v[16:19], v[12:15], v[80:95]
    s_waitcnt lgkmcnt(0)
    s_barrier
    ds_read_b64_tr_b16 v[16:17], v29 offset:0
    ds_read_b64_tr_b16 v[18:19], v29 offset:512
    ds_read_b128 v[0:3], v28 offset:0
    v_mfma_f32_32x32x16_bf16 v[48:63], v[20:23], v[8:11], v[48:63]
    ds_read_b128 v[4:7], v28 offset:4096
    v_xor_b32 v28, 32, v28
    v_mfma_f32_32x32x16_bf16 v[96:111], v[20:23], v[12:15], v[96:111]
    ds_read_b64_tr_b16 v[20:21], v29 offset:2048
    ds_read_b64_tr_b16 v[22:23], v29 offset:2560
    v_mfma_f32_32x32x16_bf16 v[64:79], v[8:11], v[24:27], v[64:79]
    v_mfma_f32_32x32x16_bf16 v[112:127], v[12:15], v[24:27], v[112:127]
    ds_read_b64_tr_b16 v[24:25], v29 offset:4096
    ds_read_b64_tr_b16 v[26:27], v29 offset:4608
    s_waitcnt lgkmcnt(4)
    v_mfma_f32_32x32x16_bf16 v[32:47], v[16:19], v[0:3], v[32:47]
    ds_read_b128 v[8:11], v28 offset:0
    ds_read_b128 v[12:15], v28 offset:4096
    v_xor_b32 v28, 96, v28
    v_mfma_f32_32x32x16_bf16 v[80:95], v[16:19], v[4:7], v[80:95]
    ds_read_b64_tr_b16 v[16:17], v29 offset:6144
    ds_read_b64_tr_b16 v[18:19], v29 offset:6656
    s_add_u32 s24, s24, 1
    s_cmp_eq_u32 s24, 3
    s_cselect_b32 s23, -2, 1
    s_cselect_b32 s24, 0, s24
    s_mul_i32 s23, s23, 24576
    s_waitcnt lgkmcnt(6)
    v_mfma_f32_32x32x16_bf16 v[48:63], v[20:23], v[0:3], v[48:63]
    v_mfma_f32_32x32x16_bf16 v[96:111], v[20:23], v[4:7], v[96:111]
    ds_read_b64_tr_b16 v[20:21], v29 offset:8192
    ds_read_b64_tr_b16 v[22:23], v29 offset:8704
    s_waitcnt lgkmcnt(6)
    v_mfma_f32_32x32x16_bf16 v[64:79], v[0:3], v[24:27], v[64:79]
    v_mfma_f32_32x32x16_bf16 v[112:127], v[4:7], v[24:27], v[112:127]
    ds_read_b64_tr_b16 v[24:25], v29 offset:10240
    ds_read_b64_tr_b16 v[26:27], v29 offset:10752
    s_waitcnt lgkmcnt(4)
    v_mfma_f32_32x32x16_bf16 v[32:47], v[16:19], v[8:11], v[32:47]
    ds_read_b128 v[0:3], v28 offset:0
    ds_read_b128 v[4:7], v28 offset:4096
    v_xor_b32 v28, 32, v28
    v_mfma_f32_32x32x16_bf16 v[80:95], v[16:19], v[12:15], v[80:95]
    ds_read_b64_tr_b16 v[16:17], v29 offset:12288
    ds_read_b64_tr_b16 v[18:19], v29 offset:12800
    s_add_u32 s21, s21, 1
    s_cmp_eq_u32 s21, 5
    s_cselect_b32 s22, -4, 1
    s_cselect_b32 s21, 0, s21
    s_mul_i32 s22, s22, 16384
    s_waitcnt lgkmcnt(6)
    v_mfma_f32_32x32x16_bf16 v[48:63], v[20:23], v[8:11], v[48:63]
    v_mfma_f32_32x32x16_bf16 v[96:111], v[20:23], v[12:15], v[96:111]
    ds_read_b64_tr_b16 v[20:21], v29 offset:14336
    ds_read_b64_tr_b16 v[22:23], v29 offset:14848
    s_waitcnt lgkmcnt(6)
    v_mfma_f32_32x32x16_bf16 v[64:79], v[8:11], v[24:27], v[64:79]
    v_mfma_f32_32x32x16_bf16 v[112:127], v[12:15], v[24:27], v[112:127]
    ds_read_b64_tr_b16 v[24:25], v29 offset:16384
    ds_read_b64_tr_b16 v[26:27], v29 offset:16896
    s_waitcnt lgkmcnt(4)
    v_mfma_f32_32x32x16_bf16 v[32:47], v[16:19], v[0:3], v[32:47]
    ds_read_b128 v[8:11], v28 offset:0
    ds_read_b128 v[12:15], v28 offset:4096
    v_xor_b32 v28, 96, v28
    v_mfma_f32_32x32x16_bf16 v[80:95], v[16:19], v[4:7], v[80:95]
    ds_read_b64_tr_b16 v[16:17], v29 offset:18432
    ds_read_b64_tr_b16 v[18:19], v29 offset:18944
    v_add_u32 v28, s22, v28
    s_waitcnt lgkmcnt(6)
    v_mfma_f32_32x32x16_bf16 v[48:63], v[20:23], v[0:3], v[48:63]
    v_mfma_f32_32x32x16_bf16 v[96:111], v[20:23], v[4:7], v[96:111]
    ds_read_b64_tr_b16 v[20:21], v29 offset:20480
    ds_read_b64_tr_b16 v[22:23], v29 offset:20992
    s_waitcnt lgkmcnt(6)
    v_mfma_f32_32x32x16_bf16 v[64:79], v[0:3], v[24:27], v[64:79]
    s_add_u32 s25, s25, 1
    s_cmp_lt_u32 s25, 16
    v_mfma_f32_32x32x16_bf16 v[112:127], v[4:7], v[24:27], v[112:127]
    ds_read_b64_tr_b16 v[24:25], v29 offset:22528
    ds_read_b64_tr_b16 v[26:27], v29 offset:23040
    v_add_u32 v29, s23, v29
    s_cbranch_scc1 P1_CLOOP
    s_waitcnt lgkmcnt(4)
    v_mfma_f32_32x32x16_bf16 v[32:47], v[16:19], v[8:11], v[32:47]
    v_mfma_f32_32x32x16_bf16 v[80:95], v[16:19], v[12:15], v[80:95]
    s_waitcnt lgkmcnt(2)
    v_mfma_f32_32x32x16_bf16 v[48:63], v[20:23], v[8:11], v[48:63]
    v_mfma_f32_32x32x16_bf16 v[96:111], v[20:23], v[12:15], v[96:111]
    s_waitcnt lgkmcnt(0)
    v_mfma_f32_32x32x16_bf16 v[64:79], v[8:11], v[24:27], v[64:79]
    v_mfma_f32_32x32x16_bf16 v[112:127], v[12:15], v[24:27], v[112:127]
    v_mbcnt_lo_u32_b32 v28, -1, 0
    v_mbcnt_hi_u32_b32 v28, -1, v28
    v_lshlrev_b32 v28, 4, v28
    s_mov_b32 s12, s98
    s_mov_b32 s13, s99
    s_mov_b32 s14, 67108864
    s_mov_b32 s15, 0x20000
    s_lshl_b32 s10, s27, 1
    s_add_u32 s10, s10, s29
    s_lshl_b32 s10, s10, 4
    s_add_u32 s10, s10, s26
    s_lshl_b32 s10, s10, 14
    s_lshl_b32 s11, s28, 12
    s_add_u32 s10, s10, s11
    s_add_u32 s10, s10, 33554432
    s_add_u32 s16, s10, 8192
    s_lshl_b32 s18, s27, 4
    s_add_u32 s18, s18, s26
    s_lshl_b32 s18, s18, 13
    s_add_u32 s18, s18, s11
    s_add_u32 s18, s18, 41943040
    s_add_u32 s11, s11, 106496
    v_add_u32 v29, s11, v28
    s_mov_b32 s17, 1048744942
    s_xor_b32 s19, s26, s29
    s_bitcmp1_b32 s19, 0
    s_cbranch_scc1 P1_EOTH
    s_nop 3
    v_cvt_pk_bf16_f32 v48, v48, v49
    v_cvt_pk_bf16_f32 v49, v50, v51
    v_cvt_pk_bf16_f32 v50, v52, v53
    v_cvt_pk_bf16_f32 v51, v54, v55
    buffer_store_dwordx4 v[48:51], v28, s[12:15], s10 offen offset:0
    ds_write_b128 v29, v[48:51] offset:0
    v_cvt_pk_bf16_f32 v56, v56, v57
    v_cvt_pk_bf16_f32 v57, v58, v59
    v_cvt_pk_bf16_f32 v58, v60, v61
    v_cvt_pk_bf16_f32 v59, v62, v63
    buffer_store_dwordx4 v[56:59], v28, s[12:15], s10 offen offset:1024
    ds_write_b128 v29, v[56:59] offset:1024
    v_cvt_pk_bf16_f32 v96, v96, v97
    v_cvt_pk_bf16_f32 v97, v98, v99
    v_cvt_pk_bf16_f32 v98, v100, v101
    v_cvt_pk_bf16_f32 v99, v102, v103
    buffer_store_dwordx4 v[96:99], v28, s[12:15], s10 offen offset:2048
    ds_write_b128 v29, v[96:99] offset:2048
    v_cvt_pk_bf16_f32 v104, v104, v105
    v_cvt_pk_bf16_f32 v105, v106, v107
    v_cvt_pk_bf16_f32 v106, v108, v109
    v_cvt_pk_bf16_f32 v107, v110, v111
    buffer_store_dwordx4 v[104:107], v28, s[12:15], s10 offen offset:3072
    ds_write_b128 v29, v[104:107] offset:3072
    v_cvt_pk_bf16_f32 v64, v64, v65
    v_cvt_pk_bf16_f32 v65, v66, v67
    v_cvt_pk_bf16_f32 v66, v68, v69
    v_cvt_pk_bf16_f32 v67, v70, v71
    buffer_store_dwordx4 v[64:67], v28, s[12:15], s16 offen offset:0
    ds_write_b128 v29, v[64:67] offset:8192
    v_cvt_pk_bf16_f32 v72, v72, v73
    v_cvt_pk_bf16_f32 v73, v74, v75
    v_cvt_pk_bf16_f32 v74, v76, v77
    v_cvt_pk_bf16_f32 v75, v78, v79
    buffer_store_dwordx4 v[72:75], v28, s[12:15], s16 offen offset:1024
    ds_write_b128 v29, v[72:75] offset:9216
    v_cvt_pk_bf16_f32 v112, v112, v113
    v_cvt_pk_bf16_f32 v113, v114, v115
    v_cvt_pk_bf16_f32 v114, v116, v117
    v_cvt_pk_bf16_f32 v115, v118, v119
    buffer_store_dwordx4 v[112:115], v28, s[12:15], s16 offen offset:2048
    ds_write_b128 v29, v[112:115] offset:10240
    v_cvt_pk_bf16_f32 v120, v120, v121
    v_cvt_pk_bf16_f32 v121, v122, v123
    v_cvt_pk_bf16_f32 v122, v124, v125
    v_cvt_pk_bf16_f32 v123, v126, v127
    buffer_store_dwordx4 v[120:123], v28, s[12:15], s16 offen offset:3072
    ds_write_b128 v29, v[120:123] offset:11264
    v_mul_f32 v32, s17, v32
    v_mul_f32 v33, s17, v33
    v_mul_f32 v34, s17, v34
    v_mul_f32 v35, s17, v35
    v_mul_f32 v36, s17, v36
    v_mul_f32 v37, s17, v37
    v_mul_f32 v38, s17, v38
    v_mul_f32 v39, s17, v39
    v_mul_f32 v40, s17, v40
    v_mul_f32 v41, s17, v41
    v_mul_f32 v42, s17, v42
    v_mul_f32 v43, s17, v43
    v_mul_f32 v44, s17, v44
    v_mul_f32 v45, s17, v45
    v_mul_f32 v46, s17, v46
    v_mul_f32 v47, s17, v47
    v_cvt_pk_bf16_f32 v32, v32, v33
    v_cvt_pk_bf16_f32 v33, v34, v35
    v_cvt_pk_bf16_f32 v34, v36, v37
    v_cvt_pk_bf16_f32 v35, v38, v39
    ds_write_b128 v29, v[32:35] offset:16384
    v_cvt_pk_bf16_f32 v40, v40, v41
    v_cvt_pk_bf16_f32 v41, v42, v43
    v_cvt_pk_bf16_f32 v42, v44, v45
    v_cvt_pk_bf16_f32 v43, v46, v47
    ds_write_b128 v29, v[40:43] offset:17408
    v_mul_f32 v80, s17, v80
    v_mul_f32 v81, s17, v81
    v_mul_f32 v82, s17, v82
    v_mul_f32 v83, s17, v83
    v_mul_f32 v84, s17, v84
    v_mul_f32 v85, s17, v85
    v_mul_f32 v86, s17, v86
    v_mul_f32 v87, s17, v87
    v_mul_f32 v88, s17, v88
    v_mul_f32 v89, s17, v89
    v_mul_f32 v90, s17, v90
    v_mul_f32 v91, s17, v91
    v_mul_f32 v92, s17, v92
    v_mul_f32 v93, s17, v93
    v_mul_f32 v94, s17, v94
    v_mul_f32 v95, s17, v95
    v_cvt_pk_bf16_f32 v80, v80, v81
    v_cvt_pk_bf16_f32 v81, v82, v83
    v_cvt_pk_bf16_f32 v82, v84, v85
    v_cvt_pk_bf16_f32 v83, v86, v87
    ds_write_b128 v29, v[80:83] offset:18432
    v_cvt_pk_bf16_f32 v88, v88, v89
    v_cvt_pk_bf16_f32 v89, v90, v91
    v_cvt_pk_bf16_f32 v90, v92, v93
    v_cvt_pk_bf16_f32 v91, v94, v95
    ds_write_b128 v29, v[88:91] offset:19456
    v_mov_b32 v31, 1
    v_mov_b32 v30, 160768
    s_waitcnt lgkmcnt(0)
    s_mov_b64 exec, 1
    ds_add_u32 v30, v31 offset:68
    s_mov_b64 exec, -1
    s_branch P1_EDONE
P1_EOTH:
    v_mul_f32 v32, s17, v32
    v_mul_f32 v33, s17, v33
    v_mul_f32 v34, s17, v34
    v_mul_f32 v35, s17, v35
    v_mul_f32 v36, s17, v36
    v_mul_f32 v37, s17, v37
    v_mul_f32 v38, s17, v38
    v_mul_f32 v39, s17, v39
    v_mul_f32 v40, s17, v40
    v_mul_f32 v41, s17, v41
    v_mul_f32 v42, s17, v42
    v_mul_f32 v43, s17, v43
    v_mul_f32 v44, s17, v44
    v_mul_f32 v45, s17, v45
    v_mul_f32 v46, s17, v46
    v_mul_f32 v47, s17, v47
    v_cvt_pk_bf16_f32 v0, v32, v33
    v_cvt_pk_bf16_f32 v1, v34, v35
    v_cvt_pk_bf16_f32 v2, v36, v37
    v_cvt_pk_bf16_f32 v3, v38, v39
    buffer_store_dwordx4 v[0:3], v28, s[12:15], s18 offen offset:0
    v_cvt_pk_bf16_f32 v4, v40, v41
    v_cvt_pk_bf16_f32 v5, v42, v43
    v_cvt_pk_bf16_f32 v6, v44, v45
    v_cvt_pk_bf16_f32 v7, v46, v47
    buffer_store_dwordx4 v[4:7], v28, s[12:15], s18 offen offset:1024
    v_mul_f32 v80, s17, v80
    v_mul_f32 v81, s17, v81
    v_mul_f32 v82, s17, v82
    v_mul_f32 v83, s17, v83
    v_mul_f32 v84, s17, v84
    v_mul_f32 v85, s17, v85
    v_mul_f32 v86, s17, v86
    v_mul_f32 v87, s17, v87
    v_mul_f32 v88, s17, v88
    v_mul_f32 v89, s17, v89
    v_mul_f32 v90, s17, v90
    v_mul_f32 v91, s17, v91
    v_mul_f32 v92, s17, v92
    v_mul_f32 v93, s17, v93
    v_mul_f32 v94, s17, v94
    v_mul_f32 v95, s17, v95
    v_cvt_pk_bf16_f32 v8, v80, v81
    v_cvt_pk_bf16_f32 v9, v82, v83
    v_cvt_pk_bf16_f32 v10, v84, v85
    v_cvt_pk_bf16_f32 v11, v86, v87
    buffer_store_dwordx4 v[8:11], v28, s[12:15], s18 offen offset:2048
    v_cvt_pk_bf16_f32 v12, v88, v89
    v_cvt_pk_bf16_f32 v13, v90, v91
    v_cvt_pk_bf16_f32 v14, v92, v93
    v_cvt_pk_bf16_f32 v15, v94, v95
    buffer_store_dwordx4 v[12:15], v28, s[12:15], s18 offen offset:3072
    v_cvt_pk_bf16_f32 v16, v48, v49
    v_cvt_pk_bf16_f32 v17, v50, v51
    v_cvt_pk_bf16_f32 v18, v52, v53
    v_cvt_pk_bf16_f32 v19, v54, v55
    buffer_store_dwordx4 v[16:19], v28, s[12:15], s10 offen offset:0
    v_cvt_pk_bf16_f32 v20, v56, v57
    v_cvt_pk_bf16_f32 v21, v58, v59
    v_cvt_pk_bf16_f32 v22, v60, v61
    v_cvt_pk_bf16_f32 v23, v62, v63
    buffer_store_dwordx4 v[20:23], v28, s[12:15], s10 offen offset:1024
    v_cvt_pk_bf16_f32 v24, v96, v97
    v_cvt_pk_bf16_f32 v25, v98, v99
    v_cvt_pk_bf16_f32 v26, v100, v101
    v_cvt_pk_bf16_f32 v27, v102, v103
    buffer_store_dwordx4 v[24:27], v28, s[12:15], s10 offen offset:2048
    v_cvt_pk_bf16_f32 v0, v104, v105
    v_cvt_pk_bf16_f32 v1, v106, v107
    v_cvt_pk_bf16_f32 v2, v108, v109
    v_cvt_pk_bf16_f32 v3, v110, v111
    buffer_store_dwordx4 v[0:3], v28, s[12:15], s10 offen offset:3072
    v_cvt_pk_bf16_f32 v4, v64, v65
    v_cvt_pk_bf16_f32 v5, v66, v67
    v_cvt_pk_bf16_f32 v6, v68, v69
    v_cvt_pk_bf16_f32 v7, v70, v71
    buffer_store_dwordx4 v[4:7], v28, s[12:15], s16 offen offset:0
    v_cvt_pk_bf16_f32 v8, v72, v73
    v_cvt_pk_bf16_f32 v9, v74, v75
    v_cvt_pk_bf16_f32 v10, v76, v77
    v_cvt_pk_bf16_f32 v11, v78, v79
    buffer_store_dwordx4 v[8:11], v28, s[12:15], s16 offen offset:1024
    v_cvt_pk_bf16_f32 v12, v112, v113
    v_cvt_pk_bf16_f32 v13, v114, v115
    v_cvt_pk_bf16_f32 v14, v116, v117
    v_cvt_pk_bf16_f32 v15, v118, v119
    buffer_store_dwordx4 v[12:15], v28, s[12:15], s16 offen offset:2048
    v_cvt_pk_bf16_f32 v16, v120, v121
    v_cvt_pk_bf16_f32 v17, v122, v123
    v_cvt_pk_bf16_f32 v18, v124, v125
    v_cvt_pk_bf16_f32 v19, v126, v127
    buffer_store_dwordx4 v[16:19], v28, s[12:15], s16 offen offset:3072
P1_EDONE:
    v_mov_b32 v30, 160768
    v_mov_b32 v31, 1
    s_getreg_b32 s34, hwreg(HW_REG_XCC_ID)
    s_and_b32 s34, s34, 15
    s_lshl_b32 s34, s34, 4
    s_add_u32 s34, s34, s27
    s_lshl_b32 s34, s34, 9
    s_add_u32 s34, s34, 26492928
    s_lshl_b32 s10, s26, 3
    v_mov_b32 v29, s10
    s_waitcnt vmcnt(0)
    s_mov_b64 exec, 1
    ds_add_rtn_u32 v31, v30, v31 offset:72
    s_waitcnt lgkmcnt(0)
    v_cmp_eq_u32 vcc, 3, v31
    s_cbranch_vccz P1_NOKVF
    s_memrealtime s[92:93]
    s_waitcnt lgkmcnt(0)
    v_mov_b32 v30, s92
    v_mov_b32 v31, s93
    buffer_store_dwordx2 v[30:31], v29, s[12:15], s34 offen
P1_NOKVF:
    s_mov_b64 exec, -1
    s_setprio 0
    v_mov_b32 v1, v28
    v_lshrrev_b32 v0, 4, v28
    v_mov_b32 v125, 160768
    s_xor_b32 s28, s26, 1
    s_lshl_b32 s18, s27, 4
    s_add_u32 s18, s18, s28
    s_lshl_b32 s18, s18, 13
    s_lshl_b32 s10, s31, 11
    s_add_u32 s18, s18, s10
    s_add_u32 s18, s18, 8388608
    s_lshl_b32 s28, s28, 2
    s_add_u32 s28, s28, s31
A_INIT:
    v_and_b32 v2, 2, v0
    v_cmp_eq_u32 vcc, 0, v2
    v_mov_b32 v3, 0x3f803f80
    v_mov_b32 v2, 0
    v_cndmask_b32 v12, v2, v3, vcc
    v_cndmask_b32 v13, v2, v3, vcc
    v_cndmask_b32 v14, v3, v2, vcc
    v_cndmask_b32 v15, v3, v2, vcc
    v_and_b32 v2, 1, v0
    v_mul_u32_u24 v2, 0xaaaa, v2
    v_add_u32 v124, 0x4444, v2
    v_mov_b32 v127, 1
    v_mov_b32 v16, 0
    v_mov_b32 v17, 0
    v_mov_b32 v18, 0
    v_mov_b32 v19, 0
    v_mov_b32 v20, 0
    v_mov_b32 v21, 0
    v_mov_b32 v22, 0
    v_mov_b32 v23, 0
    v_mov_b32 v24, 0
    v_mov_b32 v25, 0
    v_mov_b32 v26, 0
    v_mov_b32 v27, 0
    v_mov_b32 v108, 0
    v_mov_b32 v109, 0
    v_mov_b32 v110, 0
    v_mov_b32 v111, 0
    v_mov_b32 v112, 0
    v_mov_b32 v113, 0
    v_mov_b32 v114, 0
    v_mov_b32 v115, 0
    v_mov_b32 v116, 0
    v_mov_b32 v117, 0
    v_mov_b32 v118, 0
    v_mov_b32 v119, 0
    v_mov_b32 v120, 0
    v_mov_b32 v121, 0
    v_mov_b32 v122, 0
    v_mov_b32 v123, 0
    v_mov_b32 v56, 0
    v_mov_b32 v57, 0
    v_mov_b32 v58, 0
    v_mov_b32 v59, 0
    s_and_b32 s29, s26, 1
    s_lshl_b32 s10, s27, 1
    s_add_u32 s29, s29, s10
    s_mov_b32 s22, 0
    v_add_u32 v2, 106496, v1
    s_lshl_b32 s10, s3, 2
    s_add_u32 s10, s10, 160800
    v_mov_b32 v3, s10
    s_mov_b32 s25, 2
    s_cmp_lt_u32 s3, 4
    s_cselect_b32 s23, 1, 0
    s_branch A_OWc
A_OWs:
    s_sub_u32 s100, s100, 1
    s_cbranch_scc1 L_END
    s_sleep 2
A_OWc:
    ds_read_b32 v126, v125 offset:68
    s_waitcnt lgkmcnt(0)
    v_cmp_gt_i32 vcc, 2, v126
    s_cbranch_vccnz A_OWs
    ds_read_b128 v[44:47], v2 offset:0
    ds_read_b128 v[48:51], v2 offset:1024
    s_cmp_ge_u32 s3, 4
    s_cbranch_scc1 A_FARQ
    ds_read_b128 v[4:7], v92 offset:0
    ds_read_b128 v[8:11], v92 offset:1024
    s_branch A_HAVEQ
A_FARQ:
    s_branch A_QWc
A_QWs:
    s_sub_u32 s100, s100, 1
    s_cbranch_scc1 L_END
    s_sleep 1
A_QWc:
    ds_read_b32 v126, v125 offset:100
    s_waitcnt lgkmcnt(0)
    v_cmp_gt_i32 vcc, 1, v126
    s_cbranch_vccnz A_QWs
    v_readfirstlane_b32 s10, v126
    s_cmp_eq_u32 s10, 1
    s_cselect_b32 s10, 33554432, 0
    s_add_u32 s18, s18, s10
    buffer_load_dwordx4 v[4:7], v1, s[12:15], s18 offen offset:0 sc1
    buffer_load_dwordx4 v[8:11], v1, s[12:15], s18 offen offset:1024 sc1
    s_waitcnt vmcnt(0)
A_HAVEQ:
    s_waitcnt lgkmcnt(0)
    v_mfma_f32_32x32x16_bf16 v[76:91], v[44:47], v[4:7], 0
    v_mfma_f32_32x32x16_bf16 v[76:91], v[48:51], v[8:11], v[76:91]
    ds_read_b128 v[28:31], v2 offset:2048
    ds_read_b128 v[32:35], v2 offset:3072
    ds_read_b128 v[36:39], v2 offset:8192
    ds_read_b128 v[40:43], v2 offset:9216
    s_nop 7
    v_max3_f32 v60, v76, v77, v78
    v_max3_f32 v60, v60, v79, v80
    v_max3_f32 v60, v60, v81, v82
    v_max3_f32 v60, v60, v83, v84
    v_max3_f32 v60, v60, v85, v86
    v_max3_f32 v60, v60, v87, v88
    v_max3_f32 v60, v60, v89, v90
    v_max_f32 v60, v60, v91
    v_mov_b32 v126, v60
    s_nop 1
    v_permlane32_swap_b32 v60, v126
    v_max_f32 v126, v60, v126
    v_sub_f32 v60, 0, v126
    v_sub_f32 v61, 0, v126
    v_sub_f32 v62, 0, v126
    v_sub_f32 v63, 0, v126
    v_sub_f32 v64, 0, v126
    v_sub_f32 v65, 0, v126
    v_sub_f32 v66, 0, v126
    v_sub_f32 v67, 0, v126
    v_sub_f32 v68, 0, v126
    v_sub_f32 v69, 0, v126
    v_sub_f32 v70, 0, v126
    v_sub_f32 v71, 0, v126
    v_sub_f32 v72, 0, v126
    v_sub_f32 v73, 0, v126
    v_sub_f32 v74, 0, v126
    v_sub_f32 v75, 0, v126
    v_sub_f32 v76, v76, v126
    v_sub_f32 v77, v77, v126
    v_sub_f32 v78, v78, v126
    v_sub_f32 v79, v79, v126
    v_sub_f32 v80, v80, v126
    v_sub_f32 v81, v81, v126
    v_sub_f32 v82, v82, v126
    v_sub_f32 v83, v83, v126
    v_sub_f32 v84, v84, v126
    v_sub_f32 v85, v85, v126
    v_sub_f32 v86, v86, v126
    v_sub_f32 v87, v87, v126
    v_sub_f32 v88, v88, v126
    v_sub_f32 v89, v89, v126
    v_sub_f32 v90, v90, v126
    v_sub_f32 v91, v91, v126
    v_mov_b32 v126, 0
    s_branch A_ENTRY
A_SPIN:
    s_sub_u32 s100, s100, 1
    s_cbranch_scc1 L_END
    s_sleep 1
    ds_read_b32 v126, v125 offset:64
    s_waitcnt lgkmcnt(0)
    s_branch A_CHK
A_LOOP:
    s_setprio 3
    s_waitcnt lgkmcnt(0)
    v_mfma_f32_32x32x16_bf16 v[76:91], v[44:47], v[4:7], v[60:75]
    ds_read_b128 v[28:31], v2 offset:2048
    v_exp_f32 v92, v92
    v_exp_f32 v93, v93
    v_exp_f32 v94, v94
    v_mfma_f32_32x32x16_bf16 v[108:123], v[40:43], v[24:27], v[108:123]
    ds_read_b128 v[32:35], v2 offset:3072
    v_exp_f32 v95, v95
    v_exp_f32 v96, v96
    v_exp_f32 v97, v97
    v_smfmac_f32_16x16x64_bf16 v[16:19], v[12:15], v[20:27], v124
    v_exp_f32 v98, v98
    v_exp_f32 v99, v99
    v_mfma_f32_32x32x16_bf16 v[76:91], v[48:51], v[8:11], v[76:91]
    ds_read_b128 v[36:39], v2 offset:8192
    v_cvt_pk_bf16_f32 v20, v92, v93
    v_cvt_pk_bf16_f32 v21, v94, v95
    v_cvt_pk_bf16_f32 v22, v96, v97
    v_cvt_pk_bf16_f32 v23, v98, v99
    v_exp_f32 v100, v100
    v_exp_f32 v101, v101
    v_mfma_f32_32x32x16_bf16 v[108:123], v[52:55], v[20:23], v[108:123]
    ds_read_b128 v[40:43], v2 offset:9216
    v_exp_f32 v102, v102
    v_exp_f32 v103, v103
    v_exp_f32 v104, v104
    s_mov_b64 exec, 1
    ds_add_u32 v3, v127
    s_mov_b64 exec, -1
    v_exp_f32 v105, v105
    v_exp_f32 v106, v106
    v_exp_f32 v107, v107
    v_cvt_pk_bf16_f32 v24, v100, v101
    v_cvt_pk_bf16_f32 v25, v102, v103
    v_cvt_pk_bf16_f32 v26, v104, v105
    v_cvt_pk_bf16_f32 v27, v106, v107
A_ENTRY:
    s_setprio 2
    s_waitcnt lgkmcnt(0)
    v_mfma_f32_32x32x16_bf16 v[92:107], v[28:31], v[4:7], v[60:75]
    ds_read_b128 v[44:47], v2 offset:4096
    v_exp_f32 v76, v76
    v_exp_f32 v77, v77
    v_exp_f32 v78, v78
    v_mfma_f32_32x32x16_bf16 v[108:123], v[56:59], v[24:27], v[108:123]
    ds_read_b128 v[48:51], v2 offset:5120
    v_exp_f32 v79, v79
    v_exp_f32 v80, v80
    v_exp_f32 v81, v81
    v_smfmac_f32_16x16x64_bf16 v[16:19], v[12:15], v[20:27], v124
    v_exp_f32 v82, v82
    v_exp_f32 v83, v83
    v_mfma_f32_32x32x16_bf16 v[92:107], v[32:35], v[8:11], v[92:107]
    ds_read_b128 v[52:55], v2 offset:10240
    v_cvt_pk_bf16_f32 v20, v76, v77
    v_cvt_pk_bf16_f32 v21, v78, v79
    v_cvt_pk_bf16_f32 v22, v80, v81
    v_cvt_pk_bf16_f32 v23, v82, v83
    v_exp_f32 v84, v84
    v_exp_f32 v85, v85
    v_mfma_f32_32x32x16_bf16 v[108:123], v[36:39], v[20:23], v[108:123]
    ds_read_b128 v[56:59], v2 offset:11264
    v_exp_f32 v86, v86
    v_exp_f32 v87, v87
    v_exp_f32 v88, v88
    v_exp_f32 v89, v89
    v_exp_f32 v90, v90
    v_exp_f32 v91, v91
    v_cvt_pk_bf16_f32 v24, v84, v85
    v_cvt_pk_bf16_f32 v25, v86, v87
    v_cvt_pk_bf16_f32 v26, v88, v89
    v_cvt_pk_bf16_f32 v27, v90, v91
    s_setprio 1
    s_waitcnt lgkmcnt(0)
    v_mfma_f32_32x32x16_bf16 v[76:91], v[44:47], v[4:7], v[60:75]
    ds_read_b128 v[28:31], v2 offset:6144
    v_exp_f32 v92, v92
    v_exp_f32 v93, v93
    v_exp_f32 v94, v94
    v_mfma_f32_32x32x16_bf16 v[108:123], v[40:43], v[24:27], v[108:123]
    ds_read_b128 v[32:35], v2 offset:7168
    v_exp_f32 v95, v95
    v_exp_f32 v96, v96
    v_exp_f32 v97, v97
    v_smfmac_f32_16x16x64_bf16 v[16:19], v[12:15], v[20:27], v124
    v_exp_f32 v98, v98
    v_exp_f32 v99, v99
    v_mfma_f32_32x32x16_bf16 v[76:91], v[48:51], v[8:11], v[76:91]
    ds_read_b128 v[36:39], v2 offset:12288
    v_cvt_pk_bf16_f32 v20, v92, v93
    v_cvt_pk_bf16_f32 v21, v94, v95
    v_cvt_pk_bf16_f32 v22, v96, v97
    v_cvt_pk_bf16_f32 v23, v98, v99
    v_exp_f32 v100, v100
    v_exp_f32 v101, v101
    v_mfma_f32_32x32x16_bf16 v[108:123], v[52:55], v[20:23], v[108:123]
    ds_read_b128 v[40:43], v2 offset:13312
    v_exp_f32 v102, v102
    v_exp_f32 v103, v103
    v_exp_f32 v104, v104
    ds_read_b32 v126, v125 offset:64
    v_add_u32 v0, s22, v1
    s_add_u32 s22, s22, 16384
    s_cmp_ge_u32 s22, 98304
    s_cselect_b32 s22, 0, s22
    v_exp_f32 v105, v105
    v_exp_f32 v106, v106
    v_exp_f32 v107, v107
    v_cvt_pk_bf16_f32 v24, v100, v101
    v_cvt_pk_bf16_f32 v25, v102, v103
    v_cvt_pk_bf16_f32 v26, v104, v105
    v_cvt_pk_bf16_f32 v27, v106, v107
    s_setprio 0
    s_waitcnt lgkmcnt(0)
A_CHK:
    v_cmp_gt_u32 vcc, s25, v126
    s_cbranch_vccnz A_SPIN
    v_mfma_f32_32x32x16_bf16 v[92:107], v[28:31], v[4:7], v[60:75]
    ds_read_b128 v[44:47], v0 offset:0
    v_exp_f32 v76, v76
    v_exp_f32 v77, v77
    v_exp_f32 v78, v78
    v_mfma_f32_32x32x16_bf16 v[108:123], v[56:59], v[24:27], v[108:123]
    ds_read_b128 v[48:51], v0 offset:1024
    v_exp_f32 v79, v79
    v_exp_f32 v80, v80
    v_exp_f32 v81, v81
    v_smfmac_f32_16x16x64_bf16 v[16:19], v[12:15], v[20:27], v124
    v_exp_f32 v82, v82
    v_exp_f32 v83, v83
    v_mfma_f32_32x32x16_bf16 v[92:107], v[32:35], v[8:11], v[92:107]
    ds_read_b128 v[52:55], v2 offset:14336
    v_cvt_pk_bf16_f32 v20, v76, v77
    v_cvt_pk_bf16_f32 v21, v78, v79
    v_cvt_pk_bf16_f32 v22, v80, v81
    v_cvt_pk_bf16_f32 v23, v82, v83
    v_exp_f32 v84, v84
    v_exp_f32 v85, v85
    v_mfma_f32_32x32x16_bf16 v[108:123], v[36:39], v[20:23], v[108:123]
    ds_read_b128 v[56:59], v2 offset:15360
    v_exp_f32 v86, v86
    v_exp_f32 v87, v87
    v_exp_f32 v88, v88
    v_mov_b32 v2, v0
    s_add_u32 s25, s25, 1
    v_exp_f32 v89, v89
    v_exp_f32 v90, v90
    v_exp_f32 v91, v91
    v_cvt_pk_bf16_f32 v24, v84, v85
    v_cvt_pk_bf16_f32 v25, v86, v87
    v_cvt_pk_bf16_f32 v26, v88, v89
    v_cvt_pk_bf16_f32 v27, v90, v91
    s_cmp_lt_u32 s25, 18
    s_cbranch_scc1 A_LOOP
    s_waitcnt lgkmcnt(0)
    v_exp_f32 v92, v92
    v_exp_f32 v93, v93
    v_exp_f32 v94, v94
    v_mfma_f32_32x32x16_bf16 v[108:123], v[40:43], v[24:27], v[108:123]
    v_exp_f32 v95, v95
    v_exp_f32 v96, v96
    v_exp_f32 v97, v97
    v_smfmac_f32_16x16x64_bf16 v[16:19], v[12:15], v[20:27], v124
    v_exp_f32 v98, v98
    v_exp_f32 v99, v99
    v_cvt_pk_bf16_f32 v20, v92, v93
    v_cvt_pk_bf16_f32 v21, v94, v95
    v_cvt_pk_bf16_f32 v22, v96, v97
    v_cvt_pk_bf16_f32 v23, v98, v99
    v_exp_f32 v100, v100
    v_exp_f32 v101, v101
    v_mfma_f32_32x32x16_bf16 v[108:123], v[52:55], v[20:23], v[108:123]
    v_exp_f32 v102, v102
    v_exp_f32 v103, v103
    v_exp_f32 v104, v104
    s_mov_b64 exec, 1
    ds_add_u32 v3, v127
    s_mov_b64 exec, -1
    v_exp_f32 v105, v105
    v_exp_f32 v106, v106
    v_exp_f32 v107, v107
    v_cvt_pk_bf16_f32 v24, v100, v101
    v_cvt_pk_bf16_f32 v25, v102, v103
    v_cvt_pk_bf16_f32 v26, v104, v105
    v_cvt_pk_bf16_f32 v27, v106, v107
    s_nop 1
    v_mfma_f32_32x32x16_bf16 v[108:123], v[56:59], v[24:27], v[108:123]
    v_smfmac_f32_16x16x64_bf16 v[16:19], v[12:15], v[20:27], v124
    v_and_b32 v2, 256, v1
    v_cmp_eq_u32 vcc, 0, v2
    s_lshl_b32 s10, s28, 16
    s_lshl_b32 s11, s29, 11
    s_add_u32 s10, s10, s11
    s_nop 3
    s_add_u32 s35, s10, 12582912
    s_mov_b32 s11, 1904214016
    s_nop 0
    v_add_f32 v16, v16, v17
    v_add_f32 v18, v18, v19
    v_cndmask_b32 v2, v18, v16, vcc
    v_add_f32 v3, abs(v108), v2
    v_add_f32 v3, abs(v109), v3
    v_add_f32 v3, abs(v110), v3
    v_add_f32 v3, abs(v111), v3
    v_add_f32 v3, abs(v112), v3
    v_add_f32 v3, abs(v113), v3
    v_add_f32 v3, abs(v114), v3
    v_add_f32 v3, abs(v115), v3
    v_add_f32 v3, abs(v116), v3
    v_add_f32 v3, abs(v117), v3
    v_add_f32 v3, abs(v118), v3
    v_add_f32 v3, abs(v119), v3
    v_add_f32 v3, abs(v120), v3
    v_add_f32 v3, abs(v121), v3
    v_add_f32 v3, abs(v122), v3
    v_add_f32 v3, abs(v123), v3
    v_cmp_ngt_f32 vcc, s11, v3
    s_cbranch_vccnz A_FALLBACK
A_FIN:
    v_rcp_f32 v2, v2
    s_nop 0
    v_mul_f32 v108, v2, v108
    v_mul_f32 v109, v2, v109
    v_mul_f32 v110, v2, v110
    v_mul_f32 v111, v2, v111
    v_mul_f32 v112, v2, v112
    v_mul_f32 v113, v2, v113
    v_mul_f32 v114, v2, v114
    v_mul_f32 v115, v2, v115
    v_cvt_pk_bf16_f32 v20, v108, v109
    v_cvt_pk_bf16_f32 v21, v110, v111
    v_cvt_pk_bf16_f32 v22, v112, v113
    v_cvt_pk_bf16_f32 v23, v114, v115
    buffer_store_dwordx4 v[20:23], v1, s[12:15], s35 offen offset:0 sc1
    v_mul_f32 v116, v2, v116
    v_mul_f32 v117, v2, v117
    v_mul_f32 v118, v2, v118
    v_mul_f32 v119, v2, v119
    v_mul_f32 v120, v2, v120
    v_mul_f32 v121, v2, v121
    v_mul_f32 v122, v2, v122
    v_mul_f32 v123, v2, v123
    v_cvt_pk_bf16_f32 v24, v116, v117
    v_cvt_pk_bf16_f32 v25, v118, v119
    v_cvt_pk_bf16_f32 v26, v120, v121
    v_cvt_pk_bf16_f32 v27, v122, v123
    buffer_store_dwordx4 v[24:27], v1, s[12:15], s35 offen offset:1024 sc1
    s_load_dwordx2 s[36:37], s[0:1], 72
    s_setprio 0
    s_and_b32 s10, s26, 14
    s_mul_i32 s34, s10, 4352
    s_add_u32 s34, s34, 26423296
    s_lshl_b32 s10, s29, 3
    s_add_u32 s34, s34, s10
    v_lshrrev_b32 v0, 4, v1
    v_mul_u32_u24 v72, 4352, v0
    s_waitcnt vmcnt(0)
    s_mov_b64 exec, 1
    ds_add_rtn_u32 v126, v125, v127 offset:92
    s_waitcnt lgkmcnt(0)
    v_cmp_eq_u32 vcc, 7, v126
    s_cbranch_vccz G_NOFLAG
    s_mov_b64 exec, 3
    s_memrealtime s[92:93]
    s_waitcnt lgkmcnt(0)
    v_mov_b32 v2, s92
    v_mov_b32 v3, s93
    buffer_store_dwordx2 v[2:3], v72, s[12:15], s34 offen sc1
G_NOFLAG:
    s_mov_b64 exec, -1
    s_cmp_ge_u32 s3, 4
    s_cbranch_scc1 G_FIN
    s_and_b32 s38, s8, 3
    s_lshl_b32 s38, s38, 2
    s_and_b32 s10, s9, 3
    s_add_u32 s38, s38, s10
    s_lshr_b32 s39, s8, 2
    s_lshl_b32 s39, s39, 3
    s_lshr_b32 s10, s9, 2
    s_add_u32 s39, s39, s10
    s_lshl_b32 s28, s38, 2
    s_add_u32 s28, s28, s3
    s_lshl_b32 s10, s28, 16
    s_add_u32 s10, s10, 12582912
    s_add_u32 s16, s98, s10
    s_addc_u32 s17, s99, 0
    s_mov_b32 s18, 65536
    s_mov_b32 s19, 0x20000
    s_mov_b32 s20, s36
    s_mov_b32 s21, s37
    s_mov_b32 s22, 8388608
    s_mov_b32 s23, 0x20000
    v_add_u32 v2, 4096, v1
    v_lshrrev_b32 v6, 5, v0
    v_lshlrev_b32 v5, 9, v6
    v_bfe_u32 v7, v0, 2, 2
    v_lshl_add_u32 v5, v7, 6, v5
    v_bfe_u32 v7, v0, 4, 1
    v_lshl_add_u32 v5, v7, 5, v5
    v_and_b32 v7, 3, v0
    v_lshl_add_u32 v5, v7, 3, v5
    v_mov_b32 v24, 0
    v_mov_b32 v25, 0
    v_mov_b32 v26, 0
    v_mov_b32 v27, 0
    v_mov_b32 v28, 0
    v_mov_b32 v29, 0
    v_mov_b32 v30, 0
    v_mov_b32 v31, 0
    v_mov_b32 v32, 0
    v_mov_b32 v33, 0
    v_mov_b32 v34, 0
    v_mov_b32 v35, 0
    v_mov_b32 v36, 0
    v_mov_b32 v37, 0
    v_mov_b32 v38, 0
    v_mov_b32 v39, 0
    v_mov_b32 v40, 0
    v_mov_b32 v41, 0
    v_mov_b32 v42, 0
    v_mov_b32 v43, 0
    v_mov_b32 v44, 0
    v_mov_b32 v45, 0
    v_mov_b32 v46, 0
    v_mov_b32 v47, 0
    v_mov_b32 v48, 0
    v_mov_b32 v49, 0
    v_mov_b32 v50, 0
    v_mov_b32 v51, 0
    v_mov_b32 v52, 0
    v_mov_b32 v53, 0
    v_mov_b32 v54, 0
    v_mov_b32 v55, 0
    v_and_b32 v7, 31, v0
    v_lshlrev_b32 v7, 12, v7
    v_lshl_add_u32 v7, v6, 4, v7
    s_lshl_b32 s30, s28, 17
    s_lshl_b32 s11, s39, 7
    s_add_u32 s30, s30, s11
    s_add_u32 s30, s30, 2048
    s_mov_b32 s24, 0
    s_mov_b32 s25, 0
    s_mov_b32 s31, 277308739
    s_mov_b32 s29, 3
    s_and_b32 s43, s39, 0
    s_lshl_b32 s43, s43, 2
    s_andn2_b32 s10, s25, s24
    s_cbranch_scc1 G_AQ0b
G_AQ0a:
    ds_read_b32 v126, v125 offset:96
    s_waitcnt lgkmcnt(0)
    v_readfirstlane_b32 s25, v126
    s_andn2_b32 s10, s25, s24
    s_cbranch_scc1 G_AQ0b
    s_sub_u32 s100, s100, 1
    s_cbranch_scc1 L_END
    s_sleep 2
    s_branch G_AQ0a
G_AQ0b:
    s_ff1_i32_b32 s11, s10
    s_bitset1_b32 s24, s11
    s_lshl_b32 s10, s11, 11
    s_lshr_b32 s11, s31, s11
    s_and_b32 s11, s11, 15
    s_lshl_b32 s40, s11, 14
    buffer_load_dwordx4 v[56:59], v1, s[16:19], s10 offen offset:0 sc1
    buffer_load_dwordx4 v[60:63], v1, s[16:19], s10 offen offset:1024 sc1
    buffer_load_dwordx4 v[64:67], v1, s[16:19], s10 offen offset:2048 sc1
    buffer_load_dwordx4 v[68:71], v1, s[16:19], s10 offen offset:3072 sc1
    buffer_load_dwordx4 v[72:75], v2, s[16:19], s10 offen offset:0 sc1
    buffer_load_dwordx4 v[76:79], v2, s[16:19], s10 offen offset:1024 sc1
    buffer_load_dwordx4 v[80:83], v2, s[16:19], s10 offen offset:2048 sc1
    buffer_load_dwordx4 v[84:87], v2, s[16:19], s10 offen offset:3072 sc1
    s_setprio 3
    v_add_u32 v3, s40, v5
    ds_read_b64_tr_b16 v[8:9], v3 offset:0
    ds_read_b64_tr_b16 v[10:11], v3 offset:1024
    ds_read_b64_tr_b16 v[12:13], v3 offset:256
    ds_read_b64_tr_b16 v[14:15], v3 offset:1280
    s_andn2_b32 s10, s25, s24
    s_cbranch_scc1 G_AQ1b
G_AQ1a:
    ds_read_b32 v126, v125 offset:96
    s_waitcnt lgkmcnt(0)
    v_readfirstlane_b32 s25, v126
    s_andn2_b32 s10, s25, s24
    s_cbranch_scc1 G_AQ1b
    s_sub_u32 s100, s100, 1
    s_cbranch_scc1 L_END
    s_sleep 2
    s_branch G_AQ1a
G_AQ1b:
    s_ff1_i32_b32 s11, s10
    s_bitset1_b32 s24, s11
    s_lshl_b32 s10, s11, 11
    s_lshr_b32 s11, s31, s11
    s_and_b32 s11, s11, 15
    s_lshl_b32 s41, s11, 14
    buffer_load_dwordx4 v[88:91], v1, s[16:19], s10 offen offset:0 sc1
    buffer_load_dwordx4 v[92:95], v1, s[16:19], s10 offen offset:1024 sc1
    buffer_load_dwordx4 v[96:99], v1, s[16:19], s10 offen offset:2048 sc1
    buffer_load_dwordx4 v[100:103], v1, s[16:19], s10 offen offset:3072 sc1
    buffer_load_dwordx4 v[104:107], v2, s[16:19], s10 offen offset:0 sc1
    buffer_load_dwordx4 v[108:111], v2, s[16:19], s10 offen offset:1024 sc1
    buffer_load_dwordx4 v[112:115], v2, s[16:19], s10 offen offset:2048 sc1
    buffer_load_dwordx4 v[116:119], v2, s[16:19], s10 offen offset:3072 sc1
G_LOOP:
    v_add_u32 v4, s41, v5
    s_waitcnt vmcnt(15) lgkmcnt(2)
    v_mfma_f32_32x32x16_bf16 v[24:39], v[8:11], v[56:59], v[24:39]
    ds_read_b64_tr_b16 v[16:17], v3 offset:2048
    ds_read_b64_tr_b16 v[18:19], v3 offset:3072
    s_waitcnt lgkmcnt(2)
    v_mfma_f32_32x32x16_bf16 v[40:55], v[12:15], v[56:59], v[40:55]
    ds_read_b64_tr_b16 v[20:21], v3 offset:2304
    ds_read_b64_tr_b16 v[22:23], v3 offset:3328
    s_waitcnt vmcnt(14) lgkmcnt(2)
    v_mfma_f32_32x32x16_bf16 v[24:39], v[16:19], v[60:63], v[24:39]
    ds_read_b64_tr_b16 v[8:9], v3 offset:4096
    ds_read_b64_tr_b16 v[10:11], v3 offset:5120
    s_waitcnt lgkmcnt(2)
    v_mfma_f32_32x32x16_bf16 v[40:55], v[20:23], v[60:63], v[40:55]
    ds_read_b64_tr_b16 v[12:13], v3 offset:4352
    ds_read_b64_tr_b16 v[14:15], v3 offset:5376
    s_waitcnt vmcnt(13) lgkmcnt(2)
    v_mfma_f32_32x32x16_bf16 v[24:39], v[8:11], v[64:67], v[24:39]
    ds_read_b64_tr_b16 v[16:17], v3 offset:6144
    ds_read_b64_tr_b16 v[18:19], v3 offset:7168
    s_waitcnt lgkmcnt(2)
    v_mfma_f32_32x32x16_bf16 v[40:55], v[12:15], v[64:67], v[40:55]
    ds_read_b64_tr_b16 v[20:21], v3 offset:6400
    ds_read_b64_tr_b16 v[22:23], v3 offset:7424
    s_waitcnt vmcnt(12) lgkmcnt(2)
    v_mfma_f32_32x32x16_bf16 v[24:39], v[16:19], v[68:71], v[24:39]
    ds_read_b64_tr_b16 v[8:9], v3 offset:8192
    ds_read_b64_tr_b16 v[10:11], v3 offset:9216
    s_waitcnt lgkmcnt(2)
    v_mfma_f32_32x32x16_bf16 v[40:55], v[20:23], v[68:71], v[40:55]
    ds_read_b64_tr_b16 v[12:13], v3 offset:8448
    ds_read_b64_tr_b16 v[14:15], v3 offset:9472
    s_waitcnt vmcnt(11) lgkmcnt(2)
    v_mfma_f32_32x32x16_bf16 v[24:39], v[8:11], v[72:75], v[24:39]
    ds_read_b64_tr_b16 v[16:17], v3 offset:10240
    ds_read_b64_tr_b16 v[18:19], v3 offset:11264
    s_waitcnt lgkmcnt(2)
    v_mfma_f32_32x32x16_bf16 v[40:55], v[12:15], v[72:75], v[40:55]
    ds_read_b64_tr_b16 v[20:21], v3 offset:10496
    ds_read_b64_tr_b16 v[22:23], v3 offset:11520
    s_waitcnt vmcnt(10) lgkmcnt(2)
    v_mfma_f32_32x32x16_bf16 v[24:39], v[16:19], v[76:79], v[24:39]
    ds_read_b64_tr_b16 v[8:9], v3 offset:12288
    ds_read_b64_tr_b16 v[10:11], v3 offset:13312
    s_waitcnt lgkmcnt(2)
    v_mfma_f32_32x32x16_bf16 v[40:55], v[20:23], v[76:79], v[40:55]
    ds_read_b64_tr_b16 v[12:13], v3 offset:12544
    ds_read_b64_tr_b16 v[14:15], v3 offset:13568
    s_waitcnt vmcnt(9) lgkmcnt(2)
    v_mfma_f32_32x32x16_bf16 v[24:39], v[8:11], v[80:83], v[24:39]
    ds_read_b64_tr_b16 v[16:17], v3 offset:14336
    ds_read_b64_tr_b16 v[18:19], v3 offset:15360
    s_waitcnt lgkmcnt(2)
    v_mfma_f32_32x32x16_bf16 v[40:55], v[12:15], v[80:83], v[40:55]
    ds_read_b64_tr_b16 v[20:21], v3 offset:14592
    ds_read_b64_tr_b16 v[22:23], v3 offset:15616
    s_waitcnt vmcnt(8) lgkmcnt(2)
    v_mfma_f32_32x32x16_bf16 v[24:39], v[16:19], v[84:87], v[24:39]
    ds_read_b64_tr_b16 v[8:9], v4 offset:0
    ds_read_b64_tr_b16 v[10:11], v4 offset:1024
    s_waitcnt lgkmcnt(2)
    v_mfma_f32_32x32x16_bf16 v[40:55], v[20:23], v[84:87], v[40:55]
    ds_read_b64_tr_b16 v[12:13], v4 offset:256
    ds_read_b64_tr_b16 v[14:15], v4 offset:1280
    s_andn2_b32 s10, s25, s24
    s_cbranch_scc1 G_AQ2b
G_AQ2a:
    ds_read_b32 v126, v125 offset:96
    s_waitcnt lgkmcnt(0)
    v_readfirstlane_b32 s25, v126
    s_andn2_b32 s10, s25, s24
    s_cbranch_scc1 G_AQ2b
    s_sub_u32 s100, s100, 1
    s_cbranch_scc1 L_END
    s_sleep 2
    s_branch G_AQ2a
G_AQ2b:
    s_ff1_i32_b32 s11, s10
    s_bitset1_b32 s24, s11
    s_lshl_b32 s10, s11, 11
    s_lshr_b32 s11, s31, s11
    s_and_b32 s11, s11, 15
    s_lshl_b32 s40, s11, 14
    buffer_load_dwordx4 v[56:59], v1, s[16:19], s10 offen offset:0 sc1
    buffer_load_dwordx4 v[60:63], v1, s[16:19], s10 offen offset:1024 sc1
    buffer_load_dwordx4 v[64:67], v1, s[16:19], s10 offen offset:2048 sc1
    buffer_load_dwordx4 v[68:71], v1, s[16:19], s10 offen offset:3072 sc1
    buffer_load_dwordx4 v[72:75], v2, s[16:19], s10 offen offset:0 sc1
    buffer_load_dwordx4 v[76:79], v2, s[16:19], s10 offen offset:1024 sc1
    buffer_load_dwordx4 v[80:83], v2, s[16:19], s10 offen offset:2048 sc1
    buffer_load_dwordx4 v[84:87], v2, s[16:19], s10 offen offset:3072 sc1
    v_add_u32 v3, s40, v5
    s_waitcnt vmcnt(15) lgkmcnt(2)
    v_mfma_f32_32x32x16_bf16 v[24:39], v[8:11], v[88:91], v[24:39]
    ds_read_b64_tr_b16 v[16:17], v4 offset:2048
    ds_read_b64_tr_b16 v[18:19], v4 offset:3072
    s_waitcnt lgkmcnt(2)
    v_mfma_f32_32x32x16_bf16 v[40:55], v[12:15], v[88:91], v[40:55]
    ds_read_b64_tr_b16 v[20:21], v4 offset:2304
    ds_read_b64_tr_b16 v[22:23], v4 offset:3328
    s_waitcnt vmcnt(14) lgkmcnt(2)
    v_mfma_f32_32x32x16_bf16 v[24:39], v[16:19], v[92:95], v[24:39]
    ds_read_b64_tr_b16 v[8:9], v4 offset:4096
    ds_read_b64_tr_b16 v[10:11], v4 offset:5120
    s_waitcnt lgkmcnt(2)
    v_mfma_f32_32x32x16_bf16 v[40:55], v[20:23], v[92:95], v[40:55]
    ds_read_b64_tr_b16 v[12:13], v4 offset:4352
    ds_read_b64_tr_b16 v[14:15], v4 offset:5376
    s_waitcnt vmcnt(13) lgkmcnt(2)
    v_mfma_f32_32x32x16_bf16 v[24:39], v[8:11], v[96:99], v[24:39]
    ds_read_b64_tr_b16 v[16:17], v4 offset:6144
    ds_read_b64_tr_b16 v[18:19], v4 offset:7168
    s_waitcnt lgkmcnt(2)
    v_mfma_f32_32x32x16_bf16 v[40:55], v[12:15], v[96:99], v[40:55]
    ds_read_b64_tr_b16 v[20:21], v4 offset:6400
    ds_read_b64_tr_b16 v[22:23], v4 offset:7424
    s_waitcnt vmcnt(12) lgkmcnt(2)
    v_mfma_f32_32x32x16_bf16 v[24:39], v[16:19], v[100:103], v[24:39]
    ds_read_b64_tr_b16 v[8:9], v4 offset:8192
    ds_read_b64_tr_b16 v[10:11], v4 offset:9216
    s_waitcnt lgkmcnt(2)
    v_mfma_f32_32x32x16_bf16 v[40:55], v[20:23], v[100:103], v[40:55]
    ds_read_b64_tr_b16 v[12:13], v4 offset:8448
    ds_read_b64_tr_b16 v[14:15], v4 offset:9472
    s_waitcnt vmcnt(11) lgkmcnt(2)
    v_mfma_f32_32x32x16_bf16 v[24:39], v[8:11], v[104:107], v[24:39]
    ds_read_b64_tr_b16 v[16:17], v4 offset:10240
    ds_read_b64_tr_b16 v[18:19], v4 offset:11264
    s_waitcnt lgkmcnt(2)
    v_mfma_f32_32x32x16_bf16 v[40:55], v[12:15], v[104:107], v[40:55]
    ds_read_b64_tr_b16 v[20:21], v4 offset:10496
    ds_read_b64_tr_b16 v[22:23], v4 offset:11520
    s_waitcnt vmcnt(10) lgkmcnt(2)
    v_mfma_f32_32x32x16_bf16 v[24:39], v[16:19], v[108:111], v[24:39]
    ds_read_b64_tr_b16 v[8:9], v4 offset:12288
    ds_read_b64_tr_b16 v[10:11], v4 offset:13312
    s_waitcnt lgkmcnt(2)
    v_mfma_f32_32x32x16_bf16 v[40:55], v[20:23], v[108:111], v[40:55]
    ds_read_b64_tr_b16 v[12:13], v4 offset:12544
    ds_read_b64_tr_b16 v[14:15], v4 offset:13568
    s_waitcnt vmcnt(9) lgkmcnt(2)
    v_mfma_f32_32x32x16_bf16 v[24:39], v[8:11], v[112:115], v[24:39]
    ds_read_b64_tr_b16 v[16:17], v4 offset:14336
    ds_read_b64_tr_b16 v[18:19], v4 offset:15360
    s_waitcnt lgkmcnt(2)
    v_mfma_f32_32x32x16_bf16 v[40:55], v[12:15], v[112:115], v[40:55]
    ds_read_b64_tr_b16 v[20:21], v4 offset:14592
    ds_read_b64_tr_b16 v[22:23], v4 offset:15616
    s_waitcnt vmcnt(8) lgkmcnt(2)
    v_mfma_f32_32x32x16_bf16 v[24:39], v[16:19], v[116:119], v[24:39]
    ds_read_b64_tr_b16 v[8:9], v3 offset:0
    ds_read_b64_tr_b16 v[10:11], v3 offset:1024
    s_waitcnt lgkmcnt(2)
    v_mfma_f32_32x32x16_bf16 v[40:55], v[20:23], v[116:119], v[40:55]
    ds_read_b64_tr_b16 v[12:13], v3 offset:256
    ds_read_b64_tr_b16 v[14:15], v3 offset:1280
    s_andn2_b32 s10, s25, s24
    s_cbranch_scc1 G_AQ3b
G_AQ3a:
    ds_read_b32 v126, v125 offset:96
    s_waitcnt lgkmcnt(0)
    v_readfirstlane_b32 s25, v126
    s_andn2_b32 s10, s25, s24
    s_cbranch_scc1 G_AQ3b
    s_sub_u32 s100, s100, 1
    s_cbranch_scc1 L_END
    s_sleep 2
    s_branch G_AQ3a
G_AQ3b:
    s_ff1_i32_b32 s11, s10
    s_bitset1_b32 s24, s11
    s_lshl_b32 s10, s11, 11
    s_lshr_b32 s11, s31, s11
    s_and_b32 s11, s11, 15
    s_lshl_b32 s41, s11, 14
    buffer_load_dwordx4 v[88:91], v1, s[16:19], s10 offen offset:0 sc1
    buffer_load_dwordx4 v[92:95], v1, s[16:19], s10 offen offset:1024 sc1
    buffer_load_dwordx4 v[96:99], v1, s[16:19], s10 offen offset:2048 sc1
    buffer_load_dwordx4 v[100:103], v1, s[16:19], s10 offen offset:3072 sc1
    buffer_load_dwordx4 v[104:107], v2, s[16:19], s10 offen offset:0 sc1
    buffer_load_dwordx4 v[108:111], v2, s[16:19], s10 offen offset:1024 sc1
    buffer_load_dwordx4 v[112:115], v2, s[16:19], s10 offen offset:2048 sc1
    buffer_load_dwordx4 v[116:119], v2, s[16:19], s10 offen offset:3072 sc1
    s_sub_u32 s29, s29, 1
    s_cmp_lg_u32 s29, 0
    s_cbranch_scc1 G_LOOP
    v_add_u32 v4, s41, v5
    s_waitcnt vmcnt(15) lgkmcnt(2)
    v_mfma_f32_32x32x16_bf16 v[24:39], v[8:11], v[56:59], v[24:39]
    ds_read_b64_tr_b16 v[16:17], v3 offset:2048
    ds_read_b64_tr_b16 v[18:19], v3 offset:3072
    s_waitcnt lgkmcnt(2)
    v_mfma_f32_32x32x16_bf16 v[40:55], v[12:15], v[56:59], v[40:55]
    ds_read_b64_tr_b16 v[20:21], v3 offset:2304
    ds_read_b64_tr_b16 v[22:23], v3 offset:3328
    s_waitcnt vmcnt(14) lgkmcnt(2)
    v_mfma_f32_32x32x16_bf16 v[24:39], v[16:19], v[60:63], v[24:39]
    ds_read_b64_tr_b16 v[8:9], v3 offset:4096
    ds_read_b64_tr_b16 v[10:11], v3 offset:5120
    s_waitcnt lgkmcnt(2)
    v_mfma_f32_32x32x16_bf16 v[40:55], v[20:23], v[60:63], v[40:55]
    ds_read_b64_tr_b16 v[12:13], v3 offset:4352
    ds_read_b64_tr_b16 v[14:15], v3 offset:5376
    s_waitcnt vmcnt(13) lgkmcnt(2)
    v_mfma_f32_32x32x16_bf16 v[24:39], v[8:11], v[64:67], v[24:39]
    ds_read_b64_tr_b16 v[16:17], v3 offset:6144
    ds_read_b64_tr_b16 v[18:19], v3 offset:7168
    s_waitcnt lgkmcnt(2)
    v_mfma_f32_32x32x16_bf16 v[40:55], v[12:15], v[64:67], v[40:55]
    ds_read_b64_tr_b16 v[20:21], v3 offset:6400
    ds_read_b64_tr_b16 v[22:23], v3 offset:7424
    s_waitcnt vmcnt(12) lgkmcnt(2)
    v_mfma_f32_32x32x16_bf16 v[24:39], v[16:19], v[68:71], v[24:39]
    ds_read_b64_tr_b16 v[8:9], v3 offset:8192
    ds_read_b64_tr_b16 v[10:11], v3 offset:9216
    s_waitcnt lgkmcnt(2)
    v_mfma_f32_32x32x16_bf16 v[40:55], v[20:23], v[68:71], v[40:55]
    ds_read_b64_tr_b16 v[12:13], v3 offset:8448
    ds_read_b64_tr_b16 v[14:15], v3 offset:9472
    s_waitcnt vmcnt(11) lgkmcnt(2)
    v_mfma_f32_32x32x16_bf16 v[24:39], v[8:11], v[72:75], v[24:39]
    ds_read_b64_tr_b16 v[16:17], v3 offset:10240
    ds_read_b64_tr_b16 v[18:19], v3 offset:11264
    s_waitcnt lgkmcnt(2)
    v_mfma_f32_32x32x16_bf16 v[40:55], v[12:15], v[72:75], v[40:55]
    ds_read_b64_tr_b16 v[20:21], v3 offset:10496
    ds_read_b64_tr_b16 v[22:23], v3 offset:11520
    s_waitcnt vmcnt(10) lgkmcnt(2)
    v_mfma_f32_32x32x16_bf16 v[24:39], v[16:19], v[76:79], v[24:39]
    ds_read_b64_tr_b16 v[8:9], v3 offset:12288
    ds_read_b64_tr_b16 v[10:11], v3 offset:13312
    s_waitcnt lgkmcnt(2)
    v_mfma_f32_32x32x16_bf16 v[40:55], v[20:23], v[76:79], v[40:55]
    ds_read_b64_tr_b16 v[12:13], v3 offset:12544
    ds_read_b64_tr_b16 v[14:15], v3 offset:13568
    s_waitcnt vmcnt(9) lgkmcnt(2)
    v_mfma_f32_32x32x16_bf16 v[24:39], v[8:11], v[80:83], v[24:39]
    ds_read_b64_tr_b16 v[16:17], v3 offset:14336
    ds_read_b64_tr_b16 v[18:19], v3 offset:15360
    s_waitcnt lgkmcnt(2)
    v_mfma_f32_32x32x16_bf16 v[40:55], v[12:15], v[80:83], v[40:55]
    ds_read_b64_tr_b16 v[20:21], v3 offset:14592
    ds_read_b64_tr_b16 v[22:23], v3 offset:15616
    s_waitcnt vmcnt(8) lgkmcnt(2)
    v_mfma_f32_32x32x16_bf16 v[24:39], v[16:19], v[84:87], v[24:39]
    ds_read_b64_tr_b16 v[8:9], v4 offset:0
    ds_read_b64_tr_b16 v[10:11], v4 offset:1024
    s_waitcnt lgkmcnt(2)
    v_mfma_f32_32x32x16_bf16 v[40:55], v[20:23], v[84:87], v[40:55]
    ds_read_b64_tr_b16 v[12:13], v4 offset:256
    ds_read_b64_tr_b16 v[14:15], v4 offset:1280
    s_waitcnt vmcnt(7) lgkmcnt(2)
    v_mfma_f32_32x32x16_bf16 v[24:39], v[8:11], v[88:91], v[24:39]
    ds_read_b64_tr_b16 v[16:17], v4 offset:2048
    ds_read_b64_tr_b16 v[18:19], v4 offset:3072
    s_waitcnt lgkmcnt(2)
    v_mfma_f32_32x32x16_bf16 v[40:55], v[12:15], v[88:91], v[40:55]
    ds_read_b64_tr_b16 v[20:21], v4 offset:2304
    ds_read_b64_tr_b16 v[22:23], v4 offset:3328
    s_waitcnt vmcnt(6) lgkmcnt(2)
    v_mfma_f32_32x32x16_bf16 v[24:39], v[16:19], v[92:95], v[24:39]
    ds_read_b64_tr_b16 v[8:9], v4 offset:4096
    ds_read_b64_tr_b16 v[10:11], v4 offset:5120
    s_waitcnt lgkmcnt(2)
    v_mfma_f32_32x32x16_bf16 v[40:55], v[20:23], v[92:95], v[40:55]
    ds_read_b64_tr_b16 v[12:13], v4 offset:4352
    ds_read_b64_tr_b16 v[14:15], v4 offset:5376
    s_waitcnt vmcnt(5) lgkmcnt(2)
    v_mfma_f32_32x32x16_bf16 v[24:39], v[8:11], v[96:99], v[24:39]
    ds_read_b64_tr_b16 v[16:17], v4 offset:6144
    ds_read_b64_tr_b16 v[18:19], v4 offset:7168
    s_waitcnt lgkmcnt(2)
    v_mfma_f32_32x32x16_bf16 v[40:55], v[12:15], v[96:99], v[40:55]
    ds_read_b64_tr_b16 v[20:21], v4 offset:6400
    ds_read_b64_tr_b16 v[22:23], v4 offset:7424
    s_waitcnt vmcnt(4) lgkmcnt(2)
    v_mfma_f32_32x32x16_bf16 v[24:39], v[16:19], v[100:103], v[24:39]
    ds_read_b64_tr_b16 v[8:9], v4 offset:8192
    ds_read_b64_tr_b16 v[10:11], v4 offset:9216
    s_waitcnt lgkmcnt(2)
    v_mfma_f32_32x32x16_bf16 v[40:55], v[20:23], v[100:103], v[40:55]
    ds_read_b64_tr_b16 v[12:13], v4 offset:8448
    ds_read_b64_tr_b16 v[14:15], v4 offset:9472
    s_waitcnt vmcnt(3) lgkmcnt(2)
    v_mfma_f32_32x32x16_bf16 v[24:39], v[8:11], v[104:107], v[24:39]
    ds_read_b64_tr_b16 v[16:17], v4 offset:10240
    ds_read_b64_tr_b16 v[18:19], v4 offset:11264
    s_waitcnt lgkmcnt(2)
    v_mfma_f32_32x32x16_bf16 v[40:55], v[12:15], v[104:107], v[40:55]
    ds_read_b64_tr_b16 v[20:21], v4 offset:10496
    ds_read_b64_tr_b16 v[22:23], v4 offset:11520
    s_waitcnt vmcnt(2) lgkmcnt(2)
    v_mfma_f32_32x32x16_bf16 v[24:39], v[16:19], v[108:111], v[24:39]
    ds_read_b64_tr_b16 v[8:9], v4 offset:12288
    ds_read_b64_tr_b16 v[10:11], v4 offset:13312
    s_waitcnt lgkmcnt(2)
    v_mfma_f32_32x32x16_bf16 v[40:55], v[20:23], v[108:111], v[40:55]
    ds_read_b64_tr_b16 v[12:13], v4 offset:12544
    ds_read_b64_tr_b16 v[14:15], v4 offset:13568
    s_waitcnt vmcnt(1) lgkmcnt(2)
    v_mfma_f32_32x32x16_bf16 v[24:39], v[8:11], v[112:115], v[24:39]
    ds_read_b64_tr_b16 v[16:17], v4 offset:14336
    ds_read_b64_tr_b16 v[18:19], v4 offset:15360
    s_waitcnt lgkmcnt(2)
    v_mfma_f32_32x32x16_bf16 v[40:55], v[12:15], v[112:115], v[40:55]
    ds_read_b64_tr_b16 v[20:21], v4 offset:14592
    ds_read_b64_tr_b16 v[22:23], v4 offset:15616
    s_waitcnt vmcnt(0) lgkmcnt(2)
    v_mfma_f32_32x32x16_bf16 v[24:39], v[16:19], v[116:119], v[24:39]
    s_waitcnt lgkmcnt(0)
    v_mfma_f32_32x32x16_bf16 v[40:55], v[20:23], v[116:119], v[40:55]
    s_nop 9
    v_cvt_pk_bf16_f32 v8, v24, v25
    v_cvt_pk_bf16_f32 v9, v26, v27
    v_cvt_pk_bf16_f32 v10, v28, v29
    v_cvt_pk_bf16_f32 v11, v30, v31
    v_cvt_pk_bf16_f32 v12, v32, v33
    v_cvt_pk_bf16_f32 v13, v34, v35
    v_cvt_pk_bf16_f32 v14, v36, v37
    v_cvt_pk_bf16_f32 v15, v38, v39
    s_nop 1
    v_permlane32_swap_b32 v8, v10
    v_permlane32_swap_b32 v9, v11
    buffer_store_dwordx4 v[8:11], v7, s[20:23], s30 offen offset:0
    v_permlane32_swap_b32 v12, v14
    v_permlane32_swap_b32 v13, v15
    buffer_store_dwordx4 v[12:15], v7, s[20:23], s30 offen offset:32
    s_nop 0
    v_cvt_pk_bf16_f32 v16, v40, v41
    v_cvt_pk_bf16_f32 v17, v42, v43
    v_cvt_pk_bf16_f32 v18, v44, v45
    v_cvt_pk_bf16_f32 v19, v46, v47
    v_cvt_pk_bf16_f32 v20, v48, v49
    v_cvt_pk_bf16_f32 v21, v50, v51
    v_cvt_pk_bf16_f32 v22, v52, v53
    v_cvt_pk_bf16_f32 v23, v54, v55
    s_nop 1
    v_permlane32_swap_b32 v16, v18
    v_permlane32_swap_b32 v17, v19
    buffer_store_dwordx4 v[16:19], v7, s[20:23], s30 offen offset:64
    v_permlane32_swap_b32 v20, v22
    v_permlane32_swap_b32 v21, v23
    buffer_store_dwordx4 v[20:23], v7, s[20:23], s30 offen offset:96
G_FIN:
L_END:
    s_endpgm
A_FALLBACK:
    ds_read_b32 v126, v125 offset:108
    s_waitcnt lgkmcnt(0)
    v_readfirstlane_b32 s31, v126
    v_mov_b32 v108, 0
    v_mov_b32 v109, 0
    v_mov_b32 v110, 0
    v_mov_b32 v111, 0
    v_mov_b32 v112, 0
    v_mov_b32 v113, 0
    v_mov_b32 v114, 0
    v_mov_b32 v115, 0
    v_mov_b32 v116, 0
    v_mov_b32 v117, 0
    v_mov_b32 v118, 0
    v_mov_b32 v119, 0
    v_mov_b32 v120, 0
    v_mov_b32 v121, 0
    v_mov_b32 v122, 0
    v_mov_b32 v123, 0
    v_mov_b32 v2, 0
    v_mov_b32 v60, 0xff7fffff
    s_lshl_b32 s30, s29, 18
    s_mov_b32 s25, 0
A_FBL:
    s_lshr_b32 s10, s25, 2
    s_bitcmp1_b32 s31, s10
    s_cselect_b32 s11, 33554432, 0
    s_lshl_b32 s10, s10, 14
    s_add_u32 s10, s10, s11
    s_and_b32 s11, s25, 3
    s_lshl_b32 s11, s11, 11
    s_add_u32 s10, s10, s11
    s_add_u32 s10, s10, s30
    s_add_u32 s11, s10, 8192
    buffer_load_dwordx4 v[28:31], v1, s[12:15], s10 offen offset:0 sc1
    buffer_load_dwordx4 v[32:35], v1, s[12:15], s10 offen offset:1024 sc1
    buffer_load_dwordx4 v[36:39], v1, s[12:15], s11 offen offset:0 sc1
    buffer_load_dwordx4 v[40:43], v1, s[12:15], s11 offen offset:1024 sc1
    s_waitcnt vmcnt(0)
    v_mfma_f32_32x32x16_bf16 v[76:91], v[28:31], v[4:7], 0
    v_mfma_f32_32x32x16_bf16 v[76:91], v[32:35], v[8:11], v[76:91]
    s_nop 15
    v_max3_f32 v3, v76, v77, v60
    v_max3_f32 v3, v3, v78, v79
    v_max3_f32 v3, v3, v80, v81
    v_max3_f32 v3, v3, v82, v83
    v_max3_f32 v3, v3, v84, v85
    v_max3_f32 v3, v3, v86, v87
    v_max3_f32 v3, v3, v88, v89
    v_max3_f32 v3, v3, v90, v91
    v_mov_b32 v92, v3
    s_nop 1
    v_permlane32_swap_b32 v3, v92
    v_max_f32 v3, v3, v92
    v_sub_f32 v61, v60, v3
    v_exp_f32 v61, v61
    v_mov_b32 v60, v3
    v_sub_f32 v76, v76, v3
    v_sub_f32 v77, v77, v3
    v_sub_f32 v78, v78, v3
    v_sub_f32 v79, v79, v3
    v_sub_f32 v80, v80, v3
    v_sub_f32 v81, v81, v3
    v_sub_f32 v82, v82, v3
    v_sub_f32 v83, v83, v3
    v_sub_f32 v84, v84, v3
    v_sub_f32 v85, v85, v3
    v_sub_f32 v86, v86, v3
    v_sub_f32 v87, v87, v3
    v_sub_f32 v88, v88, v3
    v_sub_f32 v89, v89, v3
    v_sub_f32 v90, v90, v3
    v_sub_f32 v91, v91, v3
    v_exp_f32 v76, v76
    v_exp_f32 v77, v77
    v_exp_f32 v78, v78
    v_exp_f32 v79, v79
    v_exp_f32 v80, v80
    v_exp_f32 v81, v81
    v_exp_f32 v82, v82
    v_exp_f32 v83, v83
    v_exp_f32 v84, v84
    v_exp_f32 v85, v85
    v_exp_f32 v86, v86
    v_exp_f32 v87, v87
    v_exp_f32 v88, v88
    v_exp_f32 v89, v89
    v_exp_f32 v90, v90
    v_exp_f32 v91, v91
    v_mul_f32 v2, v2, v61
    v_mul_f32 v108, v108, v61
    v_mul_f32 v109, v109, v61
    v_mul_f32 v110, v110, v61
    v_mul_f32 v111, v111, v61
    v_mul_f32 v112, v112, v61
    v_mul_f32 v113, v113, v61
    v_mul_f32 v114, v114, v61
    v_mul_f32 v115, v115, v61
    v_mul_f32 v116, v116, v61
    v_mul_f32 v117, v117, v61
    v_mul_f32 v118, v118, v61
    v_mul_f32 v119, v119, v61
    v_mul_f32 v120, v120, v61
    v_mul_f32 v121, v121, v61
    v_mul_f32 v122, v122, v61
    v_mul_f32 v123, v123, v61
    v_add_f32 v2, v2, v76
    v_add_f32 v2, v2, v77
    v_add_f32 v2, v2, v78
    v_add_f32 v2, v2, v79
    v_add_f32 v2, v2, v80
    v_add_f32 v2, v2, v81
    v_add_f32 v2, v2, v82
    v_add_f32 v2, v2, v83
    v_add_f32 v2, v2, v84
    v_add_f32 v2, v2, v85
    v_add_f32 v2, v2, v86
    v_add_f32 v2, v2, v87
    v_add_f32 v2, v2, v88
    v_add_f32 v2, v2, v89
    v_add_f32 v2, v2, v90
    v_add_f32 v2, v2, v91
    v_cvt_pk_bf16_f32 v20, v76, v77
    v_cvt_pk_bf16_f32 v21, v78, v79
    v_cvt_pk_bf16_f32 v22, v80, v81
    v_cvt_pk_bf16_f32 v23, v82, v83
    v_cvt_pk_bf16_f32 v24, v84, v85
    v_cvt_pk_bf16_f32 v25, v86, v87
    v_cvt_pk_bf16_f32 v26, v88, v89
    v_cvt_pk_bf16_f32 v27, v90, v91
    s_nop 1
    v_mfma_f32_32x32x16_bf16 v[108:123], v[36:39], v[20:23], v[108:123]
    v_mfma_f32_32x32x16_bf16 v[108:123], v[40:43], v[24:27], v[108:123]
    s_nop 15
    s_add_u32 s25, s25, 1
    s_cmp_lt_u32 s25, 64
    s_cbranch_scc1 A_FBL
    v_mov_b32 v3, v2
    s_nop 1
    v_permlane32_swap_b32 v2, v3
    v_add_f32 v2, v2, v3
    s_branch A_FIN
L_HELPERS:
    s_cmp_ge_u32 s3, 9
    s_cbranch_scc1 L_PARTA
    s_load_dwordx2 s[36:37], s[0:1], 64
    v_and_b32 v8, 3, v0
    v_lshlrev_b32 v8, 2, v8
    v_add_u32 v8, 160768, v8
    v_and_b32 v9, 7, v0
    v_lshlrev_b32 v9, 2, v9
    v_add_u32 v9, 160768, v9
    v_mov_b32 v20, 160768
    s_waitcnt lgkmcnt(0)
    s_add_u32 s94, s96, 0x1000000
    s_addc_u32 s95, s97, 0
    v_lshlrev_b32 v1, 4, v0
    v_and_b32 v6, 15, v0
    v_lshlrev_b32 v6, 3, v6
    s_mov_b32 s12, s98
    s_mov_b32 s13, s99
    s_mov_b32 s14, 67108864
    s_mov_b32 s15, 0x20000
    s_mul_i32 s34, s27, 4352
    s_add_u32 s34, s34, 26353664
    s_and_b32 s30, s26, 1
    s_lshl_b32 s10, s27, 1
    s_add_u32 s30, s30, s10
    s_lshl_b32 s30, s30, 18
    s_xor_b32 s31, s26, 1
    s_mov_b32 s47, 0
    s_getreg_b32 s35, hwreg(HW_REG_XCC_ID)
    s_and_b32 s35, s35, 15
    s_lshl_b32 s35, s35, 4
    s_add_u32 s35, s35, s27
    s_lshl_b32 s35, s35, 9
    s_add_u32 s35, s35, 26492928
    s_mov_b32 s48, 0
    s_mov_b32 s49, 0
    s_lshl_b32 s10, s26, 3
    s_add_u32 s10, s10, 128
    v_mov_b32 v17, s10
    s_barrier
    s_barrier
    s_barrier
    s_barrier
    s_mov_b64 exec, 1
    s_memrealtime s[92:93]
    s_waitcnt lgkmcnt(0)
    v_mov_b32 v18, s92
    v_mov_b32 v19, s93
    buffer_store_dwordx2 v[18:19], v17, s[12:15], s35 offen
    s_mov_b64 exec, -1
    v_and_b32 v16, 31, v0
    v_lshlrev_b32 v16, 3, v16
    s_lshl_b32 s44, 1, s26
    s_mov_b32 s45, 0
    s_mov_b32 s46, 0x4000
    s_mov_b32 s21, 0
    s_mov_b32 s25, 1
    s_and_b32 s38, s8, 3
    s_lshl_b32 s38, s38, 2
    s_and_b32 s10, s9, 3
    s_add_u32 s38, s38, s10
    s_lshr_b32 s39, s8, 2
    s_lshl_b32 s39, s39, 3
    s_lshr_b32 s10, s9, 2
    s_add_u32 s39, s39, s10
    v_lshrrev_b32 v5, 5, v0
    v_lshlrev_b32 v5, 2, v5
    v_bfe_u32 v7, v0, 2, 2
    v_add_u32 v5, v5, v7
    v_lshlrev_b32 v5, 11, v5
    v_bfe_u32 v7, v0, 4, 1
    v_lshl_add_u32 v5, v7, 6, v5
    v_and_b32 v7, 3, v0
    v_lshl_add_u32 v10, v7, 4, v5
    v_add_u32 v11, 15360, v10
    v_add_u32 v12, 30720, v10
    v_add_u32 v13, 46080, v10
    s_lshl_b32 s11, s39, 7
    s_sub_u32 s18, 2097152, s11
    s_add_u32 s16, s36, s11
    s_addc_u32 s17, s37, 0
    s_mov_b32 s19, 0x20000
    s_setprio 3
    s_barrier
    s_barrier
    s_barrier
    s_barrier
    s_barrier
    s_barrier
    s_barrier
    s_barrier
    buffer_load_dwordx2 v[18:19], v6, s[12:15], s35 offen offset:128 sc1
    s_barrier
    s_barrier
    s_barrier
    s_barrier
    s_waitcnt vmcnt(0)
    v_cmp_lt_u64 vcc, s[96:97], v[18:19]
    v_cmp_gt_u64 s[92:93], s[94:95], v[18:19]
    s_and_b64 vcc, vcc, s[92:93]
    s_cmp_eq_u64 vcc, -1
    s_cselect_b32 s50, 1, 2
    v_mov_b32 v3, s50
    ds_write_b32 v20, v3 offset:104
    s_branch W8_E2c
W8_E2s:
    s_sub_u32 s100, s100, 1
    s_cbranch_scc1 L_END
    s_sleep 1
W8_E2c:
    ds_read_b32 v3, v20 offset:72
    s_waitcnt lgkmcnt(0)
    v_cmp_gt_i32 vcc, 4, v3
    s_cbranch_vccnz W8_E2s
W8_LOOP:
    s_cmp_eq_u32 s47, 0
    s_cbranch_scc1 W8_POLL
    s_andn2_b32 s10, s45, s44
    s_cbranch_scc1 W8_HAVE
W8_POLL:
    buffer_load_dwordx2 v[18:19], v6, s[12:15], s35 offen sc1
    s_add_u32 s49, s49, 1
    s_sub_u32 s100, s100, 1
    s_cbranch_scc1 L_END
    s_cmp_eq_u32 s50, 1
    s_cbranch_scc1 W8_PL
    buffer_load_dwordx2 v[14:15], v6, s[12:15], s34 offen sc1
    s_waitcnt vmcnt(0)
    v_cmp_lt_u64 vcc, s[96:97], v[14:15]
    v_cmp_gt_u64 s[92:93], s[94:95], v[14:15]
    s_and_b64 vcc, vcc, s[92:93]
    s_and_b32 s45, vcc_lo, 0xffff
    s_sub_u32 s46, s46, 1
    s_cselect_b32 s45, 0xffff, s45
W8_PL:
    v_mov_b32 v3, s25
    s_waitcnt vmcnt(0)
    ds_write_b32 v20, v3 offset:64
    v_cmp_lt_u64 vcc, s[96:97], v[18:19]
    v_cmp_gt_u64 s[92:93], s[94:95], v[18:19]
    s_and_b64 vcc, vcc, s[92:93]
    s_and_b32 s48, vcc_lo, 0xffff
    s_or_b32 s45, s45, s48
    s_cmp_lg_u32 s47, 0
    s_cbranch_scc1 W8_QD
    s_bitcmp1_b32 s45, s31
    s_cselect_b32 s47, 2, 0
    s_bitcmp1_b32 s48, s31
    s_cselect_b32 s47, 1, s47
    v_mov_b32 v3, s47
    ds_write_b32 v20, v3 offset:100
W8_QD:
    s_andn2_b32 s10, s45, s44
    s_cbranch_scc1 W8_HAVE
    s_sleep 2
    s_branch W8_POLL
W8_NOSLOT:
    v_mov_b32 v3, s25
    s_waitcnt vmcnt(0)
    ds_write_b32 v20, v3 offset:64
    s_sub_u32 s100, s100, 1
    s_cbranch_scc1 L_END
    s_sleep 4
    s_branch W8_LOOP
W8_HAVE:
    s_sub_u32 s24, s25, 5
    ds_read_b32 v3, v9 offset:32
    s_waitcnt lgkmcnt(0)
    v_cmp_gt_i32 vcc, s24, v3
    s_cbranch_vccnz W8_NOSLOT
    s_lshr_b32 s11, s10, s26
    s_cselect_b32 s11, s11, s10
    s_cselect_b32 s20, s26, 0
    s_ff1_i32_b32 s11, s11
    s_add_u32 s11, s11, s20
    s_bitset1_b32 s44, s11
    s_lshl_b32 s20, s11, 14
    s_add_u32 s20, s20, s30
    s_bitcmp1_b32 s48, s11
    s_cselect_b32 s10, 33554432, 0
    s_add_u32 s20, s20, s10
    s_mov_b32 m0, s21
    s_add_u32 s21, s21, 4096
    buffer_load_dwordx4 v1, s[12:15], s20 offen offset:0 sc1 lds
    buffer_load_dwordx4 v1, s[12:15], s20 offen offset:1024 sc1 lds
    buffer_load_dwordx4 v1, s[12:15], s20 offen offset:2048 sc1 lds
    buffer_load_dwordx4 v1, s[12:15], s20 offen offset:3072 sc1 lds
    s_add_u32 s20, s20, 4096
    s_mov_b32 m0, s21
    s_add_u32 s21, s21, 4096
    buffer_load_dwordx4 v1, s[12:15], s20 offen offset:0 sc1 lds
    buffer_load_dwordx4 v1, s[12:15], s20 offen offset:1024 sc1 lds
    buffer_load_dwordx4 v1, s[12:15], s20 offen offset:2048 sc1 lds
    buffer_load_dwordx4 v1, s[12:15], s20 offen offset:3072 sc1 lds
    s_add_u32 s20, s20, 4096
    s_mov_b32 m0, s21
    s_add_u32 s21, s21, 4096
    buffer_load_dwordx4 v1, s[12:15], s20 offen offset:0 sc1 lds
    buffer_load_dwordx4 v1, s[12:15], s20 offen offset:1024 sc1 lds
    buffer_load_dwordx4 v1, s[12:15], s20 offen offset:2048 sc1 lds
    buffer_load_dwordx4 v1, s[12:15], s20 offen offset:3072 sc1 lds
    s_add_u32 s20, s20, 4096
    s_mov_b32 m0, s21
    s_add_u32 s21, s21, 4096
    buffer_load_dwordx4 v1, s[12:15], s20 offen offset:0 sc1 lds
    buffer_load_dwordx4 v1, s[12:15], s20 offen offset:1024 sc1 lds
    buffer_load_dwordx4 v1, s[12:15], s20 offen offset:2048 sc1 lds
    buffer_load_dwordx4 v1, s[12:15], s20 offen offset:3072 sc1 lds
    s_add_u32 s20, s20, 4096
    s_cmp_ge_u32 s21, 98304
    s_cselect_b32 s21, 0, s21
    v_mov_b32 v3, s25
    s_add_u32 s25, s25, 1
    s_waitcnt vmcnt(16)
    ds_write_b32 v20, v3 offset:64
    s_cmp_lt_u32 s25, 16
    s_cbranch_scc1 W8_LOOP
    s_bitset1_b32 s48, s26
    v_mov_b32 v7, s48
    ds_write_b32 v20, v7 offset:108
    v_mov_b32 v3, 17
    s_waitcnt vmcnt(0)
    ds_write_b32 v20, v3 offset:64
    s_mul_i32 s34, s38, 4352
    s_add_u32 s34, s34, 26423296
    s_mov_b32 s41, 277308739
    s_mov_b32 s42, 1985303875
    s_mov_b32 s25, 0
    s_mov_b32 s44, 0
    s_mov_b32 s51, 0
    s_mov_b32 s46, 0x4000
W8_WLOOP:
    s_cmp_lg_u32 s25, 3
    s_cbranch_scc1 W8_WNC
    s_branch W8_CVc
W8_CVs:
    s_sub_u32 s100, s100, 1
    s_cbranch_scc1 L_END
    s_sleep 4
W8_CVc:
    ds_read_b32 v3, v20 offset:84
    s_waitcnt lgkmcnt(0)
    v_cmp_gt_i32 vcc, 4, v3
    s_cbranch_vccnz W8_CVs
W8_WNC:
    s_and_b32 s24, s42, 15
    s_add_u32 s24, s24, 8
    ds_read_b32 v3, v9 offset:32
    s_waitcnt lgkmcnt(0)
    v_cmp_gt_i32 vcc, s24, v3
    s_cbranch_vccnz W8_WSKIP
    s_lshl_b32 s20, s25, 18
    s_and_b32 s21, s41, 15
    s_lshl_b32 s21, s21, 14
    s_lshl_b32 s10, s25, 2
    s_bitset1_b32 s44, s10
    s_mov_b32 m0, s21
    s_add_u32 s21, s21, 4096
    buffer_load_dwordx4 v10, s[16:19], s20 offen offset:0 lds
    buffer_load_dwordx4 v11, s[16:19], s20 offen offset:1024 lds
    buffer_load_dwordx4 v12, s[16:19], s20 offen offset:2048 lds
    buffer_load_dwordx4 v13, s[16:19], s20 offen offset:3072 lds
    s_add_u32 s20, s20, 65536
    s_mov_b32 m0, s21
    s_add_u32 s21, s21, 4096
    buffer_load_dwordx4 v10, s[16:19], s20 offen offset:0 lds
    buffer_load_dwordx4 v11, s[16:19], s20 offen offset:1024 lds
    buffer_load_dwordx4 v12, s[16:19], s20 offen offset:2048 lds
    buffer_load_dwordx4 v13, s[16:19], s20 offen offset:3072 lds
    s_add_u32 s20, s20, 65536
    s_mov_b32 m0, s21
    s_add_u32 s21, s21, 4096
    buffer_load_dwordx4 v10, s[16:19], s20 offen offset:0 lds
    buffer_load_dwordx4 v11, s[16:19], s20 offen offset:1024 lds
    buffer_load_dwordx4 v12, s[16:19], s20 offen offset:2048 lds
    buffer_load_dwordx4 v13, s[16:19], s20 offen offset:3072 lds
    s_add_u32 s20, s20, 65536
    s_mov_b32 m0, s21
    s_add_u32 s21, s21, 4096
    buffer_load_dwordx4 v10, s[16:19], s20 offen offset:0 lds
    buffer_load_dwordx4 v11, s[16:19], s20 offen offset:1024 lds
    buffer_load_dwordx4 v12, s[16:19], s20 offen offset:2048 lds
    buffer_load_dwordx4 v13, s[16:19], s20 offen offset:3072 lds
    s_add_u32 s20, s20, 65536
    s_lshr_b32 s41, s41, 4
    s_lshr_b32 s42, s42, 4
    s_waitcnt vmcnt(32)
    s_add_u32 s25, s25, 1
    s_cmp_lt_u32 s25, 8
    s_cbranch_scc1 W8_WLOOP
    s_branch W8_OWc
W8_OWs:
    s_sub_u32 s100, s100, 1
    s_cbranch_scc1 L_END
    s_sleep 4
W8_OWc:
    ds_read_b32 v3, v20 offset:92
    s_waitcnt lgkmcnt(0)
    v_cmp_gt_i32 vcc, 4, v3
    s_cbranch_vccnz W8_OWs
W8_WSKIP:
    s_cmp_lt_u32 s25, 8
    s_cbranch_scc1 W8_WNEXT
W8_OPOLL:
    buffer_load_dwordx2 v[14:15], v16, s[12:15], s34 offen sc1
    s_waitcnt vmcnt(0)
    v_cmp_lt_u64 vcc, s[96:97], v[14:15]
    v_cmp_gt_u64 s[92:93], s[94:95], v[14:15]
    s_and_b64 vcc, vcc, s[92:93]
    s_lshr_b32 s10, vcc_lo, 1
    s_and_b32 s45, vcc_lo, s10
    s_lshr_b32 s10, s45, 2
    s_and_b32 s45, s45, s10
    s_sub_u32 s46, s46, 1
    s_cselect_b32 s45, -1, s45
    s_and_b32 s45, s45, s44
    s_branch W8_OXc
W8_OXs:
    s_sub_u32 s100, s100, 1
    s_cbranch_scc1 L_END
    s_sleep 1
W8_OXc:
    ds_read_b32 v3, v20 offset:92
    s_waitcnt lgkmcnt(0)
    v_cmp_gt_i32 vcc, 8, v3
    s_cbranch_vccnz W8_OXs
    v_mov_b32 v3, s45
    ds_write_b32 v20, v3 offset:96
    s_cmp_eq_u32 s45, 0x11111111
    s_cbranch_scc1 W8_DONE
W8_WNEXT:
    s_sub_u32 s100, s100, 1
    s_cbranch_scc1 L_END
    s_sleep 8
    s_cmp_lt_u32 s25, 8
    s_cbranch_scc1 W8_WLOOP
    s_branch W8_OPOLL
W8_DONE:
    s_endpgm
L_PARTA:
    s_load_dwordx8 s[36:43], s[0:1], 0
    s_load_dwordx4 s[44:47], s[0:1], 32
    s_load_dwordx4 s[48:51], s[0:1], 64
    s_sub_u32 s3, s3, 9
    s_lshl_b32 s56, s27, 1
    s_lshr_b32 s10, s3, 1
    s_add_u32 s56, s56, s10
    s_lshl_b32 s56, s56, 4
    s_add_u32 s56, s56, s26
    s_lshl_b32 s56, s56, 14
    s_and_b32 s10, s3, 1
    s_lshl_b32 s10, s10, 13
    s_add_u32 s56, s56, s10
    s_lshl_b32 s57, s27, 4
    s_add_u32 s57, s57, s26
    s_lshl_b32 s57, s57, 13
    s_lshl_b32 s10, s3, 11
    s_add_u32 s57, s57, s10
    s_add_u32 s57, s57, 8388608
    s_mul_i32 s101, s27, 4352
    s_add_u32 s101, s101, 26353664
    s_lshl_b32 s10, s26, 3
    s_add_u32 s101, s101, s10
    s_getreg_b32 s8, hwreg(HW_REG_XCC_ID)
    s_and_b32 s8, s8, 15
    s_lshl_b32 s8, s8, 4
    s_add_u32 s8, s8, s27
    s_lshl_b32 s8, s8, 9
    s_add_u32 s8, s8, 26492928
    s_add_u32 s8, s8, 256
    s_mov_b32 s28, s27
    s_lshl_b32 s35, s26, 3
    s_lshl_b32 s29, s26, 2
    s_add_u32 s29, s29, s3
    s_lshl_b32 s27, s28, 6
    s_add_u32 s27, s27, s29
    s_mul_i32 s30, s3, 15616
    s_add_u32 s30, s30, 98304
    v_and_b32 v1, 7, v0
    v_lshrrev_b32 v2, 3, v0
    s_lshl_b32 s10, s29, 5
    v_lshl_add_u32 v3, v2, 2, s10
    s_lshl_b32 s11, s28, 7
    v_lshl_add_u32 v4, v1, 4, s11
    v_lshl_add_u32 v120, v3, 11, v4
    v_lshl_add_u32 v122, v3, 12, v4
    v_lshlrev_b32 v121, 11, v4
    v_lshl_add_u32 v121, v2, 4, v121
    s_lshr_b32 s31, s29, 4
    s_lshl_b32 s31, s31, 10
    s_and_b32 s26, s29, 7
    s_lshl_b32 s26, s26, 7
    s_add_u32 s31, s31, s26
    s_and_b32 s26, s29, 8
    s_add_u32 s31, s31, s26
    v_add_u32 v121, s31, v121
    v_and_b32 v123, 15, v0
    v_lshlrev_b32 v123, 3, v123
    v_lshlrev_b32 v124, 4, v0
    v_and_b32 v1, 15, v0
    v_lshrrev_b32 v2, 4, v0
    v_lshl_add_u32 v3, v2, 3, s10
    v_lshl_add_u32 v4, v1, 3, s11
    v_lshl_add_u32 v9, v3, 11, v4
    v_add_u32 v6, -6144, v9
    v_add_u32 v7, -4096, v9
    v_add_u32 v8, -2048, v9
    v_add_u32 v10, 4096, v9
    v_add_u32 v11, 8192, v9
    v_add_u32 v12, 12288, v9
    v_lshlrev_b32 v13, 2, v4
    v_lshrrev_b32 v14, 1, v4
    v_mul_u32_u24 v14, 4224, v14
    v_lshlrev_b32 v15, 1, v3
    v_sub_u32 v15, 4080, v15
    v_add_u32 v15, v15, v14
    v_lshl_add_u32 v14, v2, 4, v14
    s_lshl_b32 s33, s27, 12
    s_mov_b32 s32, 0xffff0000
    s_mul_i32 s34, s28, 4352
    s_add_u32 s34, s34, 26214400
    s_mul_i32 s31, s27, 4224
    s_add_u32 s31, s31, 16777216
    s_add_u32 s26, s31, 4096
    v_and_b32 v1, 3, v0
    v_lshlrev_b32 v1, 2, v1
    v_add_u32 v1, 160768, v1
    s_waitcnt lgkmcnt(0)
    s_add_u32 s94, s96, 0x1000000
    s_addc_u32 s95, s97, 0
    s_mov_b32 s12, s98
    s_mov_b32 s13, s99
    s_mov_b32 s14, 67108864
    s_mov_b32 s15, 0x20000
    s_mov_b32 s16, s38
    s_mov_b32 s17, s39
    s_mov_b32 s18, 4194304
    s_mov_b32 s19, 0x20000
    s_mov_b32 s20, s40
    s_mov_b32 s21, s41
    s_mov_b32 s22, 4194304
    s_mov_b32 s23, 0x20000
    s_mov_b32 s52, s42
    s_mov_b32 s53, s43
    s_mov_b32 s54, 8192
    s_mov_b32 s55, 0x20000
    s_barrier
    s_barrier
    s_barrier
    s_barrier
    s_barrier
    s_barrier
    s_barrier
    s_barrier
    s_barrier
    s_barrier
    s_barrier
    s_barrier
    s_barrier
    s_barrier
    s_barrier
    s_barrier
    v_mov_b32 v1, 160768
    s_branch PA_C0c
PA_C0s:
    s_sub_u32 s100, s100, 1
    s_cbranch_scc1 L_END
    s_sleep 4
PA_C0c:
    ds_read_b32 v2, v1 offset:104
    s_waitcnt lgkmcnt(0)
    v_cmp_gt_i32 vcc, 1, v2
    s_cbranch_vccnz PA_C0s
    v_readfirstlane_b32 s9, v2
    v_cmp_eq_u32 vcc, 1, v2
    s_cbranch_vccnz PA_C3
    s_branch PA_C1c
PA_C1s:
    s_sub_u32 s100, s100, 1
    s_cbranch_scc1 L_END
    s_sleep 2
PA_C1c:
    ds_read_b32 v2, v1 offset:72
    s_waitcnt lgkmcnt(0)
    v_cmp_gt_i32 vcc, 4, v2
    s_cbranch_vccnz PA_C1s
    v_add_u32 v2, 4096, v124
    s_add_u32 s10, s56, 33554432
    s_add_u32 s11, s57, 33554432
    buffer_load_dwordx4 v[64:67], v124, s[12:15], s10 offen offset:0 sc1
    buffer_load_dwordx4 v[68:71], v124, s[12:15], s10 offen offset:1024 sc1
    buffer_load_dwordx4 v[72:75], v124, s[12:15], s10 offen offset:2048 sc1
    buffer_load_dwordx4 v[76:79], v124, s[12:15], s10 offen offset:3072 sc1
    buffer_load_dwordx4 v[80:83], v2, s[12:15], s10 offen offset:0 sc1
    buffer_load_dwordx4 v[84:87], v2, s[12:15], s10 offen offset:1024 sc1
    buffer_load_dwordx4 v[88:91], v2, s[12:15], s10 offen offset:2048 sc1
    buffer_load_dwordx4 v[92:95], v2, s[12:15], s10 offen offset:3072 sc1
    buffer_load_dwordx4 v[96:99], v124, s[12:15], s11 offen offset:0 sc1
    buffer_load_dwordx4 v[100:103], v124, s[12:15], s11 offen offset:1024 sc1
    s_waitcnt vmcnt(0)
    buffer_store_dwordx4 v[64:67], v124, s[12:15], s56 offen offset:0 sc1
    buffer_store_dwordx4 v[68:71], v124, s[12:15], s56 offen offset:1024 sc1
    buffer_store_dwordx4 v[72:75], v124, s[12:15], s56 offen offset:2048 sc1
    buffer_store_dwordx4 v[76:79], v124, s[12:15], s56 offen offset:3072 sc1
    buffer_store_dwordx4 v[80:83], v2, s[12:15], s56 offen offset:0 sc1
    buffer_store_dwordx4 v[84:87], v2, s[12:15], s56 offen offset:1024 sc1
    buffer_store_dwordx4 v[88:91], v2, s[12:15], s56 offen offset:2048 sc1
    buffer_store_dwordx4 v[92:95], v2, s[12:15], s56 offen offset:3072 sc1
    buffer_store_dwordx4 v[96:99], v124, s[12:15], s57 offen offset:0 sc1
    buffer_store_dwordx4 v[100:103], v124, s[12:15], s57 offen offset:1024 sc1
    v_mov_b32 v2, 1
    v_mov_b32 v3, 0
    s_waitcnt vmcnt(0)
    s_mov_b64 exec, 1
    ds_add_rtn_u32 v2, v1, v2 offset:112
    s_waitcnt lgkmcnt(0)
    v_cmp_eq_u32 vcc, 3, v2
    s_cbranch_vccz PA_C2
    s_memrealtime s[92:93]
    s_waitcnt lgkmcnt(0)
    v_mov_b32 v126, s92
    v_mov_b32 v127, s93
    buffer_store_dwordx2 v[126:127], v3, s[12:15], s101 offen sc1
PA_C2:
    s_mov_b64 exec, -1
PA_C3:
    s_branch PA_W0c
PA_W0s:
    s_sub_u32 s100, s100, 1
    s_cbranch_scc1 L_END
    s_sleep 4
PA_W0c:
    ds_read_b32 v2, v1 offset:64
    s_waitcnt lgkmcnt(0)
    v_cmp_gt_i32 vcc, 5, v2
    s_cbranch_vccnz PA_W0s
    s_setprio 3
    buffer_load_dwordx4 v[56:59], v13, s[52:55], 0 offen offset:0
    buffer_load_dwordx4 v[60:63], v13, s[52:55], 0 offen offset:16
    buffer_load_dwordx2 v[16:17], v6, s[16:19], 0 offen offset:0
    buffer_load_dwordx2 v[18:19], v7, s[16:19], 0 offen offset:0
    buffer_load_dwordx2 v[20:21], v8, s[16:19], 0 offen offset:0
    buffer_load_dwordx2 v[22:23], v9, s[16:19], 0 offen offset:0
    buffer_load_dwordx2 v[24:25], v9, s[16:19], 0 offen offset:2048
    buffer_load_dwordx2 v[26:27], v10, s[16:19], 0 offen offset:0
    buffer_load_dwordx2 v[28:29], v10, s[16:19], 0 offen offset:2048
    buffer_load_dwordx2 v[30:31], v11, s[16:19], 0 offen offset:0
    buffer_load_dwordx2 v[32:33], v11, s[16:19], 0 offen offset:2048
    buffer_load_dwordx2 v[34:35], v12, s[16:19], 0 offen offset:0
    buffer_load_dwordx2 v[36:37], v12, s[16:19], 0 offen offset:2048
    buffer_load_dwordx2 v[38:39], v9, s[20:23], 0 offen offset:0
    buffer_load_dwordx2 v[40:41], v9, s[20:23], 0 offen offset:2048
    buffer_load_dwordx2 v[42:43], v10, s[20:23], 0 offen offset:0
    buffer_load_dwordx2 v[44:45], v10, s[20:23], 0 offen offset:2048
    buffer_load_dwordx2 v[46:47], v11, s[20:23], 0 offen offset:0
    buffer_load_dwordx2 v[48:49], v11, s[20:23], 0 offen offset:2048
    buffer_load_dwordx2 v[50:51], v12, s[20:23], 0 offen offset:0
    buffer_load_dwordx2 v[52:53], v12, s[20:23], 0 offen offset:2048
    s_add_u32 s16, s44, s33
    s_addc_u32 s17, s45, 0
    s_mov_b32 s18, 4096
    s_mov_b32 s19, 0x20000
    s_mov_b32 s20, s46
    s_mov_b32 s21, s47
    s_mov_b32 s22, 2048
    s_mov_b32 s23, 0x20000
    s_waitcnt vmcnt(8)
    v_lshlrev_b32 v64, 16, v56
    v_and_b32 v66, s32, v56
    v_lshlrev_b32 v68, 16, v57
    v_and_b32 v70, s32, v57
    v_lshlrev_b32 v65, 16, v58
    v_and_b32 v67, s32, v58
    v_lshlrev_b32 v69, 16, v59
    v_and_b32 v71, s32, v59
    v_lshlrev_b32 v72, 16, v16
    v_and_b32 v73, s32, v16
    v_lshlrev_b32 v74, 16, v18
    v_and_b32 v75, s32, v18
    v_lshlrev_b32 v76, 16, v20
    v_and_b32 v77, s32, v20
    v_lshlrev_b32 v78, 16, v22
    v_and_b32 v79, s32, v22
    v_lshlrev_b32 v80, 16, v24
    v_and_b32 v81, s32, v24
    v_lshlrev_b32 v82, 16, v26
    v_and_b32 v83, s32, v26
    v_lshlrev_b32 v84, 16, v28
    v_and_b32 v85, s32, v28
    v_lshlrev_b32 v86, 16, v30
    v_and_b32 v87, s32, v30
    v_lshlrev_b32 v88, 16, v32
    v_and_b32 v89, s32, v32
    v_lshlrev_b32 v90, 16, v34
    v_and_b32 v91, s32, v34
    v_lshlrev_b32 v92, 16, v36
    v_and_b32 v93, s32, v36
    v_pk_mul_f32 v[94:95], v[72:73], v[70:71]
    v_pk_mul_f32 v[96:97], v[74:75], v[70:71]
    v_pk_mul_f32 v[98:99], v[76:77], v[70:71]
    v_pk_mul_f32 v[100:101], v[78:79], v[70:71]
    v_pk_mul_f32 v[102:103], v[80:81], v[70:71]
    v_pk_mul_f32 v[104:105], v[82:83], v[70:71]
    v_pk_mul_f32 v[106:107], v[84:85], v[70:71]
    v_pk_mul_f32 v[108:109], v[86:87], v[70:71]
    v_pk_fma_f32 v[94:95], v[74:75], v[68:69], v[94:95]
    v_pk_fma_f32 v[96:97], v[76:77], v[68:69], v[96:97]
    v_pk_fma_f32 v[98:99], v[78:79], v[68:69], v[98:99]
    v_pk_fma_f32 v[100:101], v[80:81], v[68:69], v[100:101]
    v_pk_fma_f32 v[102:103], v[82:83], v[68:69], v[102:103]
    v_pk_fma_f32 v[104:105], v[84:85], v[68:69], v[104:105]
    v_pk_fma_f32 v[106:107], v[86:87], v[68:69], v[106:107]
    v_pk_fma_f32 v[108:109], v[88:89], v[68:69], v[108:109]
    v_pk_fma_f32 v[94:95], v[76:77], v[66:67], v[94:95]
    v_pk_fma_f32 v[96:97], v[78:79], v[66:67], v[96:97]
    v_pk_fma_f32 v[98:99], v[80:81], v[66:67], v[98:99]
    v_pk_fma_f32 v[100:101], v[82:83], v[66:67], v[100:101]
    v_pk_fma_f32 v[102:103], v[84:85], v[66:67], v[102:103]
    v_pk_fma_f32 v[104:105], v[86:87], v[66:67], v[104:105]
    v_pk_fma_f32 v[106:107], v[88:89], v[66:67], v[106:107]
    v_pk_fma_f32 v[108:109], v[90:91], v[66:67], v[108:109]
    v_pk_fma_f32 v[94:95], v[78:79], v[64:65], v[94:95]
    v_pk_fma_f32 v[96:97], v[80:81], v[64:65], v[96:97]
    v_pk_fma_f32 v[98:99], v[82:83], v[64:65], v[98:99]
    v_pk_fma_f32 v[100:101], v[84:85], v[64:65], v[100:101]
    v_pk_fma_f32 v[102:103], v[86:87], v[64:65], v[102:103]
    v_pk_fma_f32 v[104:105], v[88:89], v[64:65], v[104:105]
    v_pk_fma_f32 v[106:107], v[90:91], v[64:65], v[106:107]
    v_pk_fma_f32 v[108:109], v[92:93], v[64:65], v[108:109]
    s_waitcnt vmcnt(0)
    v_lshlrev_b32 v72, 16, v38
    v_and_b32 v73, s32, v38
    v_lshlrev_b32 v74, 16, v40
    v_and_b32 v75, s32, v40
    v_lshlrev_b32 v76, 16, v42
    v_and_b32 v77, s32, v42
    v_lshlrev_b32 v78, 16, v44
    v_and_b32 v79, s32, v44
    v_lshlrev_b32 v80, 16, v46
    v_and_b32 v81, s32, v46
    v_lshlrev_b32 v82, 16, v48
    v_and_b32 v83, s32, v48
    v_lshlrev_b32 v84, 16, v50
    v_and_b32 v85, s32, v50
    v_lshlrev_b32 v86, 16, v52
    v_and_b32 v87, s32, v52
    v_pk_mul_f32 v[94:95], v[94:95], v[72:73]
    v_pk_mul_f32 v[96:97], v[96:97], v[74:75]
    v_pk_mul_f32 v[98:99], v[98:99], v[76:77]
    v_pk_mul_f32 v[100:101], v[100:101], v[78:79]
    v_pk_mul_f32 v[102:103], v[102:103], v[80:81]
    v_pk_mul_f32 v[104:105], v[104:105], v[82:83]
    v_pk_mul_f32 v[106:107], v[106:107], v[84:85]
    v_pk_mul_f32 v[108:109], v[108:109], v[86:87]
    v_cvt_pk_bf16_f32 v112, v108, v106
    v_cvt_pk_bf16_f32 v113, v104, v102
    v_cvt_pk_bf16_f32 v114, v100, v98
    v_cvt_pk_bf16_f32 v115, v96, v94
    v_cvt_pk_bf16_f32 v116, v109, v107
    v_cvt_pk_bf16_f32 v117, v105, v103
    v_cvt_pk_bf16_f32 v118, v101, v99
    v_cvt_pk_bf16_f32 v119, v97, v95
    s_cmp_eq_u32 s9, 1
    s_cbranch_scc1 PA_SP1
    s_mov_b32 s10, 16777216
    buffer_store_dwordx4 v[112:115], v15, s[12:15], s10 offen sc1
    s_mov_b32 s10, 16781440
    buffer_store_dwordx4 v[116:119], v15, s[12:15], s10 offen sc1
    s_branch PA_SE1
PA_SP1:
    s_mov_b32 s10, 16777216
    buffer_store_dwordx4 v[112:115], v15, s[12:15], s10 offen
    s_mov_b32 s10, 16781440
    buffer_store_dwordx4 v[116:119], v15, s[12:15], s10 offen
PA_SE1:
    v_lshlrev_b32 v64, 16, v60
    v_and_b32 v66, s32, v60
    v_lshlrev_b32 v68, 16, v61
    v_and_b32 v70, s32, v61
    v_lshlrev_b32 v65, 16, v62
    v_and_b32 v67, s32, v62
    v_lshlrev_b32 v69, 16, v63
    v_and_b32 v71, s32, v63
    v_lshlrev_b32 v72, 16, v17
    v_and_b32 v73, s32, v17
    v_lshlrev_b32 v74, 16, v19
    v_and_b32 v75, s32, v19
    v_lshlrev_b32 v76, 16, v21
    v_and_b32 v77, s32, v21
    v_lshlrev_b32 v78, 16, v23
    v_and_b32 v79, s32, v23
    v_lshlrev_b32 v80, 16, v25
    v_and_b32 v81, s32, v25
    v_lshlrev_b32 v82, 16, v27
    v_and_b32 v83, s32, v27
    v_lshlrev_b32 v84, 16, v29
    v_and_b32 v85, s32, v29
    v_lshlrev_b32 v86, 16, v31
    v_and_b32 v87, s32, v31
    v_lshlrev_b32 v88, 16, v33
    v_and_b32 v89, s32, v33
    v_lshlrev_b32 v90, 16, v35
    v_and_b32 v91, s32, v35
    v_lshlrev_b32 v92, 16, v37
    v_and_b32 v93, s32, v37
    v_pk_mul_f32 v[94:95], v[72:73], v[70:71]
    v_pk_mul_f32 v[96:97], v[74:75], v[70:71]
    v_pk_mul_f32 v[98:99], v[76:77], v[70:71]
    v_pk_mul_f32 v[100:101], v[78:79], v[70:71]
    v_pk_mul_f32 v[102:103], v[80:81], v[70:71]
    v_pk_mul_f32 v[104:105], v[82:83], v[70:71]
    v_pk_mul_f32 v[106:107], v[84:85], v[70:71]
    v_pk_mul_f32 v[108:109], v[86:87], v[70:71]
    v_pk_fma_f32 v[94:95], v[74:75], v[68:69], v[94:95]
    v_pk_fma_f32 v[96:97], v[76:77], v[68:69], v[96:97]
    v_pk_fma_f32 v[98:99], v[78:79], v[68:69], v[98:99]
    v_pk_fma_f32 v[100:101], v[80:81], v[68:69], v[100:101]
    v_pk_fma_f32 v[102:103], v[82:83], v[68:69], v[102:103]
    v_pk_fma_f32 v[104:105], v[84:85], v[68:69], v[104:105]
    v_pk_fma_f32 v[106:107], v[86:87], v[68:69], v[106:107]
    v_pk_fma_f32 v[108:109], v[88:89], v[68:69], v[108:109]
    v_pk_fma_f32 v[94:95], v[76:77], v[66:67], v[94:95]
    v_pk_fma_f32 v[96:97], v[78:79], v[66:67], v[96:97]
    v_pk_fma_f32 v[98:99], v[80:81], v[66:67], v[98:99]
    v_pk_fma_f32 v[100:101], v[82:83], v[66:67], v[100:101]
    v_pk_fma_f32 v[102:103], v[84:85], v[66:67], v[102:103]
    v_pk_fma_f32 v[104:105], v[86:87], v[66:67], v[104:105]
    v_pk_fma_f32 v[106:107], v[88:89], v[66:67], v[106:107]
    v_pk_fma_f32 v[108:109], v[90:91], v[66:67], v[108:109]
    v_pk_fma_f32 v[94:95], v[78:79], v[64:65], v[94:95]
    v_pk_fma_f32 v[96:97], v[80:81], v[64:65], v[96:97]
    v_pk_fma_f32 v[98:99], v[82:83], v[64:65], v[98:99]
    v_pk_fma_f32 v[100:101], v[84:85], v[64:65], v[100:101]
    v_pk_fma_f32 v[102:103], v[86:87], v[64:65], v[102:103]
    v_pk_fma_f32 v[104:105], v[88:89], v[64:65], v[104:105]
    v_pk_fma_f32 v[106:107], v[90:91], v[64:65], v[106:107]
    v_pk_fma_f32 v[108:109], v[92:93], v[64:65], v[108:109]
    v_lshlrev_b32 v72, 16, v39
    v_and_b32 v73, s32, v39
    v_lshlrev_b32 v74, 16, v41
    v_and_b32 v75, s32, v41
    v_lshlrev_b32 v76, 16, v43
    v_and_b32 v77, s32, v43
    v_lshlrev_b32 v78, 16, v45
    v_and_b32 v79, s32, v45
    v_lshlrev_b32 v80, 16, v47
    v_and_b32 v81, s32, v47
    v_lshlrev_b32 v82, 16, v49
    v_and_b32 v83, s32, v49
    v_lshlrev_b32 v84, 16, v51
    v_and_b32 v85, s32, v51
    v_lshlrev_b32 v86, 16, v53
    v_and_b32 v87, s32, v53
    v_pk_mul_f32 v[94:95], v[94:95], v[72:73]
    v_pk_mul_f32 v[96:97], v[96:97], v[74:75]
    v_pk_mul_f32 v[98:99], v[98:99], v[76:77]
    v_pk_mul_f32 v[100:101], v[100:101], v[78:79]
    v_pk_mul_f32 v[102:103], v[102:103], v[80:81]
    v_pk_mul_f32 v[104:105], v[104:105], v[82:83]
    v_pk_mul_f32 v[106:107], v[106:107], v[84:85]
    v_pk_mul_f32 v[108:109], v[108:109], v[86:87]
    v_cvt_pk_bf16_f32 v112, v108, v106
    v_cvt_pk_bf16_f32 v113, v104, v102
    v_cvt_pk_bf16_f32 v114, v100, v98
    v_cvt_pk_bf16_f32 v115, v96, v94
    v_cvt_pk_bf16_f32 v116, v109, v107
    v_cvt_pk_bf16_f32 v117, v105, v103
    v_cvt_pk_bf16_f32 v118, v101, v99
    v_cvt_pk_bf16_f32 v119, v97, v95
    s_cmp_eq_u32 s9, 1
    s_cbranch_scc1 PA_SP2
    s_mov_b32 s10, 16785664
    buffer_store_dwordx4 v[112:115], v15, s[12:15], s10 offen sc1
    s_mov_b32 s10, 16789888
    buffer_store_dwordx4 v[116:119], v15, s[12:15], s10 offen sc1
    s_branch PA_SE2
PA_SP2:
    s_mov_b32 s10, 16785664
    buffer_store_dwordx4 v[112:115], v15, s[12:15], s10 offen
    s_mov_b32 s10, 16789888
    buffer_store_dwordx4 v[116:119], v15, s[12:15], s10 offen
PA_SE2:
    s_cmp_lg_u32 s29, 0
    s_cbranch_scc1 PA_S1END
    v_mov_b32 v8, 0
    v_mov_b32 v9, 0
    v_mov_b32 v10, 0
    v_mov_b32 v11, 0
    s_cmp_eq_u32 s9, 1
    s_cbranch_scc1 PA_SP3
    s_mov_b32 s10, 16781312
    buffer_store_dwordx4 v[8:11], v14, s[12:15], s10 offen sc1
    s_mov_b32 s10, 16785536
    buffer_store_dwordx4 v[8:11], v14, s[12:15], s10 offen sc1
    s_mov_b32 s10, 16789760
    buffer_store_dwordx4 v[8:11], v14, s[12:15], s10 offen sc1
    s_mov_b32 s10, 16793984
    buffer_store_dwordx4 v[8:11], v14, s[12:15], s10 offen sc1
    s_branch PA_SE3
PA_SP3:
    s_mov_b32 s10, 16781312
    buffer_store_dwordx4 v[8:11], v14, s[12:15], s10 offen
    s_mov_b32 s10, 16785536
    buffer_store_dwordx4 v[8:11], v14, s[12:15], s10 offen
    s_mov_b32 s10, 16789760
    buffer_store_dwordx4 v[8:11], v14, s[12:15], s10 offen
    s_mov_b32 s10, 16793984
    buffer_store_dwordx4 v[8:11], v14, s[12:15], s10 offen
PA_SE3:
PA_S1END:
    v_mov_b32 v1, 160844
    v_mov_b32 v2, 1
    v_mov_b32 v3, s35
    s_waitcnt vmcnt(0)
    s_mov_b64 exec, 1
    ds_add_rtn_u32 v126, v1, v2
    s_mov_b32 s25, 0x4000
    s_waitcnt lgkmcnt(0)
    v_readfirstlane_b32 s24, v126
    s_cmp_lg_u32 s24, 3
    s_cbranch_scc1 PA_NOSIG1
    s_memrealtime s[92:93]
    s_waitcnt lgkmcnt(0)
    v_mov_b32 v126, s92
    v_mov_b32 v127, s93
    buffer_store_dwordx2 v[126:127], v3, s[12:15], s8 offen
    s_cmp_eq_u32 s9, 1
    s_cbranch_scc1 PA_NOSIG1
    buffer_store_dwordx2 v[126:127], v3, s[12:15], s34 offen sc1
PA_NOSIG1:
    s_mov_b64 exec, -1
    v_and_b32 v5, 7, v0
    v_lshlrev_b32 v5, 2, v5
    v_add_u32 v5, 160768, v5
    s_branch PA_W1c
PA_W1s:
    s_sub_u32 s100, s100, 1
    s_cbranch_scc1 L_END
    s_sleep 4
PA_W1c:
    ds_read_b32 v6, v5 offset:32
    s_waitcnt lgkmcnt(0)
    v_cmp_gt_i32 vcc, 1, v6
    s_cbranch_vccnz PA_W1s
    v_add_u32 v118, -512, v124
    v_add_u32 v119, 512, v124
    s_lshl_b32 s10, s27, 1
    v_mov_b32 v117, s10
    s_add_u32 m0, s30, 10368
    buffer_load_ushort v125, v117, s[20:23], 0 offen
    buffer_load_dwordx4 v118, s[16:19], 0 offen lds
    s_add_u32 m0, s30, 11392
    s_nop 0
    buffer_load_dwordx4 v119, s[16:19], 0 offen offset:0 lds
    buffer_load_dwordx4 v119, s[16:19], 0 offen offset:1024 lds
    buffer_load_dwordx4 v119, s[16:19], 0 offen offset:2048 lds
    buffer_load_dwordx4 v119, s[16:19], 0 offen offset:3072 lds
    s_mov_b32 s52, s48
    s_mov_b32 s53, s49
    s_mov_b32 s54, 2097152
    s_mov_b32 s55, 0x20000
    s_lshl_b32 s10, s27, 11
    v_lshlrev_b32 v5, 5, v0
    buffer_load_dword v127, v5, s[52:55], s10 offen
    v_and_b32 v5, 15, v0
    v_lshrrev_b32 v6, 4, v0
    v_lshrrev_b32 v3, 1, v5
    v_lshlrev_b32 v4, 2, v6
    v_sub_u32 v4, v4, v3
    v_lshlrev_b32 v4, 2, v4
    v_and_b32 v3, 1, v5
    v_xor_b32 v3, 1, v3
    v_mul_u32_u24 v3, 5184, v3
    s_add_u32 s10, s30, 476
    v_add3_u32 v8, v4, v3, s10
    v_add_u32 v9, 1024, v8
    v_add_u32 v10, 2048, v8
    v_add_u32 v11, 3072, v8
    v_lshlrev_b32 v3, 5, v5
    v_lshl_add_u32 v4, v6, 4, v3
    s_add_u32 s10, s30, 10848
    v_add_u32 v12, s10, v4
    v_lshl_add_u32 v14, v6, 3, v3
    s_add_u32 s10, s30, 504
    v_sub_u32 v13, s10, v14
    v_mov_b32 v80, 0
    v_mov_b32 v81, 0
    v_mov_b32 v82, 0
    v_mov_b32 v83, 0
    v_mov_b32 v84, 0
    v_mov_b32 v85, 0
    v_mov_b32 v86, 0
    v_mov_b32 v87, 0
    v_mov_b32 v88, 0
    v_mov_b32 v89, 0
    v_mov_b32 v90, 0
    v_mov_b32 v91, 0
    v_mov_b32 v92, 0
    v_mov_b32 v93, 0
    v_mov_b32 v94, 0
    v_mov_b32 v95, 0
    v_mov_b32 v96, 0
    v_mov_b32 v97, 0
    v_mov_b32 v98, 0
    v_mov_b32 v99, 0
    v_mov_b32 v100, 0
    v_mov_b32 v101, 0
    v_mov_b32 v102, 0
    v_mov_b32 v103, 0
    v_mov_b32 v104, 0
    v_mov_b32 v105, 0
    v_mov_b32 v106, 0
    v_mov_b32 v107, 0
    v_mov_b32 v108, 0
    v_mov_b32 v109, 0
    v_mov_b32 v110, 0
    v_mov_b32 v111, 0
    v_add_u32 v7, 2, v124
    s_cmp_lg_u32 s24, 3
    s_cbranch_scc1 PA_LWAIT1
PA_POLL1:
    s_sleep 4
    buffer_load_dwordx2 v[126:127], v123, s[12:15], s8 offen sc1
    s_sub_u32 s25, s25, 1
    s_cbranch_scc1 PA_GOT1
    s_waitcnt vmcnt(0)
    v_cmp_lt_u64 vcc, s[96:97], v[126:127]
    v_cmp_gt_u64 s[92:93], s[94:95], v[126:127]
    s_and_b64 vcc, vcc, s[92:93]
    s_cmp_eq_u32 s9, 1
    s_cbranch_scc1 PA_PT1
    s_mov_b64 s[10:11], vcc
    buffer_load_dwordx2 v[126:127], v123, s[12:15], s34 offen sc1
    s_waitcnt vmcnt(0)
    v_cmp_lt_u64 vcc, s[96:97], v[126:127]
    v_cmp_gt_u64 s[92:93], s[94:95], v[126:127]
    s_and_b64 vcc, vcc, s[92:93]
    s_or_b64 vcc, vcc, s[10:11]
PA_PT1:
    s_cmp_lg_u64 vcc, -1
    s_cbranch_scc1 PA_POLL1
PA_GOT1:
    ds_write_b32 v1, v2 offset:4
    s_branch PA_GO1
PA_LWAIT1:
    s_sub_u32 s100, s100, 1
    s_cbranch_scc1 L_END
    s_sleep 4
    ds_read_b32 v126, v1 offset:4
    s_waitcnt lgkmcnt(0)
    v_cmp_ne_u32 vcc, 1, v126
    s_cbranch_vccnz PA_LWAIT1
PA_GO1:
    s_add_u32 m0, s30, 0
    s_nop 0
    buffer_load_dwordx4 v124, s[12:15], s31 offen offset:0 sc1 lds
    buffer_load_dwordx4 v124, s[12:15], s31 offen offset:1024 sc1 lds
    buffer_load_dwordx4 v124, s[12:15], s31 offen offset:2048 sc1 lds
    buffer_load_dwordx4 v124, s[12:15], s31 offen offset:3072 sc1 lds
    s_add_u32 m0, s30, 4096
    s_mov_b64 exec, 15
    buffer_load_dwordx4 v124, s[12:15], s26 offen sc1 lds
    s_mov_b64 exec, -1
    s_add_u32 m0, s30, 5184
    s_nop 0
    buffer_load_dwordx4 v7, s[12:15], s31 offen offset:0 sc1 lds
    buffer_load_dwordx4 v7, s[12:15], s31 offen offset:1024 sc1 lds
    buffer_load_dwordx4 v7, s[12:15], s31 offen offset:2048 sc1 lds
    buffer_load_dwordx4 v7, s[12:15], s31 offen offset:3072 sc1 lds
    s_add_u32 m0, s30, 9280
    s_mov_b64 exec, 15
    buffer_load_dwordx4 v7, s[12:15], s26 offen sc1 lds
    s_mov_b64 exec, -1
    s_add_u32 s34, s34, 69632
    s_add_u32 s8, s8, 128
    s_mov_b32 s25, 8
    s_waitcnt vmcnt(0)
    s_mov_b32 s16, s36
    s_mov_b32 s17, s37
    s_mov_b32 s18, 4194304
    s_mov_b32 s19, 0x20000
    v_and_b32 v3, 3, v0
    v_lshl_add_u32 v3, v3, 11, v120
    buffer_load_dword v116, v3, s[16:19], 0 offen
PA_CVL:
    ds_read2_b32 v[16:17], v11 offset0:128 offset1:129
    ds_read2_b32 v[18:19], v11 offset0:130 offset1:131
    ds_read_b128 v[48:51], v12 offset:0
    ds_read2_b32 v[20:21], v11 offset0:0 offset1:1
    ds_read2_b32 v[22:23], v11 offset0:2 offset1:3
    ds_read_b128 v[52:55], v12 offset:512
    ds_read2_b32 v[24:25], v10 offset0:128 offset1:129
    ds_read2_b32 v[26:27], v10 offset0:130 offset1:131
    ds_read_b128 v[56:59], v12 offset:1024
    ds_read2_b32 v[28:29], v10 offset0:0 offset1:1
    ds_read2_b32 v[30:31], v10 offset0:2 offset1:3
    ds_read_b128 v[60:63], v12 offset:1536
    ds_read2_b32 v[32:33], v9 offset0:128 offset1:129
    ds_read2_b32 v[34:35], v9 offset0:130 offset1:131
    ds_read_b128 v[64:67], v12 offset:2048
    ds_read2_b32 v[36:37], v9 offset0:0 offset1:1
    ds_read2_b32 v[38:39], v9 offset0:2 offset1:3
    ds_read_b128 v[68:71], v12 offset:2560
    ds_read2_b32 v[40:41], v8 offset0:128 offset1:129
    ds_read2_b32 v[42:43], v8 offset0:130 offset1:131
    ds_read_b128 v[72:75], v12 offset:3072
    ds_read2_b32 v[44:45], v8 offset0:0 offset1:1
    ds_read2_b32 v[46:47], v8 offset0:2 offset1:3
    ds_read_b128 v[76:79], v12 offset:3584
    v_add_u32 v8, -64, v8
    v_add_u32 v9, -64, v9
    v_add_u32 v10, -64, v10
    v_add_u32 v11, -64, v11
    v_add_u32 v12, -64, v12
    s_waitcnt lgkmcnt(12)
    v_mfma_f32_16x16x32_bf16 v[80:83], v[16:19], v[48:51], v[80:83]
    v_mfma_f32_16x16x32_bf16 v[84:87], v[16:19], v[52:55], v[84:87]
    v_mfma_f32_16x16x32_bf16 v[88:91], v[16:19], v[56:59], v[88:91]
    v_mfma_f32_16x16x32_bf16 v[92:95], v[16:19], v[60:63], v[92:95]
    v_mfma_f32_16x16x32_bf16 v[84:87], v[20:23], v[48:51], v[84:87]
    v_mfma_f32_16x16x32_bf16 v[88:91], v[20:23], v[52:55], v[88:91]
    v_mfma_f32_16x16x32_bf16 v[92:95], v[20:23], v[56:59], v[92:95]
    v_mfma_f32_16x16x32_bf16 v[96:99], v[20:23], v[60:63], v[96:99]
    v_mfma_f32_16x16x32_bf16 v[88:91], v[24:27], v[48:51], v[88:91]
    v_mfma_f32_16x16x32_bf16 v[92:95], v[24:27], v[52:55], v[92:95]
    v_mfma_f32_16x16x32_bf16 v[96:99], v[24:27], v[56:59], v[96:99]
    v_mfma_f32_16x16x32_bf16 v[100:103], v[24:27], v[60:63], v[100:103]
    v_mfma_f32_16x16x32_bf16 v[92:95], v[28:31], v[48:51], v[92:95]
    v_mfma_f32_16x16x32_bf16 v[96:99], v[28:31], v[52:55], v[96:99]
    v_mfma_f32_16x16x32_bf16 v[100:103], v[28:31], v[56:59], v[100:103]
    v_mfma_f32_16x16x32_bf16 v[104:107], v[28:31], v[60:63], v[104:107]
    s_waitcnt lgkmcnt(0)
    v_mfma_f32_16x16x32_bf16 v[96:99], v[16:19], v[64:67], v[96:99]
    v_mfma_f32_16x16x32_bf16 v[100:103], v[16:19], v[68:71], v[100:103]
    v_mfma_f32_16x16x32_bf16 v[104:107], v[16:19], v[72:75], v[104:107]
    v_mfma_f32_16x16x32_bf16 v[108:111], v[16:19], v[76:79], v[108:111]
    v_mfma_f32_16x16x32_bf16 v[100:103], v[20:23], v[64:67], v[100:103]
    v_mfma_f32_16x16x32_bf16 v[104:107], v[20:23], v[68:71], v[104:107]
    v_mfma_f32_16x16x32_bf16 v[108:111], v[20:23], v[72:75], v[108:111]
    v_mfma_f32_16x16x32_bf16 v[104:107], v[24:27], v[64:67], v[104:107]
    v_mfma_f32_16x16x32_bf16 v[108:111], v[24:27], v[68:71], v[108:111]
    v_mfma_f32_16x16x32_bf16 v[108:111], v[28:31], v[64:67], v[108:111]
    v_mfma_f32_16x16x32_bf16 v[96:99], v[32:35], v[48:51], v[96:99]
    v_mfma_f32_16x16x32_bf16 v[100:103], v[32:35], v[52:55], v[100:103]
    v_mfma_f32_16x16x32_bf16 v[104:107], v[32:35], v[56:59], v[104:107]
    v_mfma_f32_16x16x32_bf16 v[108:111], v[32:35], v[60:63], v[108:111]
    v_mfma_f32_16x16x32_bf16 v[100:103], v[36:39], v[48:51], v[100:103]
    v_mfma_f32_16x16x32_bf16 v[104:107], v[36:39], v[52:55], v[104:107]
    v_mfma_f32_16x16x32_bf16 v[108:111], v[36:39], v[56:59], v[108:111]
    v_mfma_f32_16x16x32_bf16 v[104:107], v[40:43], v[48:51], v[104:107]
    v_mfma_f32_16x16x32_bf16 v[108:111], v[40:43], v[52:55], v[108:111]
    v_mfma_f32_16x16x32_bf16 v[108:111], v[44:47], v[48:51], v[108:111]
    s_sub_u32 s25, s25, 1
    s_cmp_lg_u32 s25, 0
    s_cbranch_scc1 PA_CVL
    s_setprio 3
    ds_read_b64 v[16:17], v13 offset:3584
    ds_read_b64 v[18:19], v13 offset:3072
    ds_read_b64 v[20:21], v13 offset:2560
    ds_read_b64 v[22:23], v13 offset:2048
    ds_read_b64 v[24:25], v13 offset:1536
    ds_read_b64 v[26:27], v13 offset:1024
    ds_read_b64 v[28:29], v13 offset:512
    ds_read_b64 v[30:31], v13 offset:0
    v_lshlrev_b32 v125, 16, v125
    s_add_u32 s33, s33, 22020096
    v_lshlrev_b32 v14, 1, v14
    s_waitcnt lgkmcnt(7)
    v_and_b32 v48, s32, v17
    v_lshlrev_b32 v49, 16, v17
    v_and_b32 v50, s32, v16
    v_lshlrev_b32 v51, 16, v16
    v_fmac_f32 v80, v125, v48
    v_fmac_f32 v81, v125, v49
    v_fmac_f32 v82, v125, v50
    v_fmac_f32 v83, v125, v51
    v_cvt_pk_bf16_f32 v64, v80, v81
    v_cvt_pk_bf16_f32 v65, v82, v83
    s_waitcnt lgkmcnt(6)
    v_and_b32 v52, s32, v19
    v_lshlrev_b32 v53, 16, v19
    v_and_b32 v54, s32, v18
    v_lshlrev_b32 v55, 16, v18
    v_fmac_f32 v84, v125, v52
    v_fmac_f32 v85, v125, v53
    v_fmac_f32 v86, v125, v54
    v_fmac_f32 v87, v125, v55
    v_cvt_pk_bf16_f32 v66, v84, v85
    v_cvt_pk_bf16_f32 v67, v86, v87
    s_waitcnt lgkmcnt(5)
    v_and_b32 v56, s32, v21
    v_lshlrev_b32 v57, 16, v21
    v_and_b32 v58, s32, v20
    v_lshlrev_b32 v59, 16, v20
    v_fmac_f32 v88, v125, v56
    v_fmac_f32 v89, v125, v57
    v_fmac_f32 v90, v125, v58
    v_fmac_f32 v91, v125, v59
    v_cvt_pk_bf16_f32 v68, v88, v89
    v_cvt_pk_bf16_f32 v69, v90, v91
    s_waitcnt lgkmcnt(4)
    v_and_b32 v60, s32, v23
    v_lshlrev_b32 v61, 16, v23
    v_and_b32 v62, s32, v22
    v_lshlrev_b32 v63, 16, v22
    v_fmac_f32 v92, v125, v60
    v_fmac_f32 v93, v125, v61
    v_fmac_f32 v94, v125, v62
    v_fmac_f32 v95, v125, v63
    v_cvt_pk_bf16_f32 v70, v92, v93
    v_cvt_pk_bf16_f32 v71, v94, v95
    s_waitcnt lgkmcnt(3)
    v_and_b32 v48, s32, v25
    v_lshlrev_b32 v49, 16, v25
    v_and_b32 v50, s32, v24
    v_lshlrev_b32 v51, 16, v24
    v_fmac_f32 v96, v125, v48
    v_fmac_f32 v97, v125, v49
    v_fmac_f32 v98, v125, v50
    v_fmac_f32 v99, v125, v51
    v_cvt_pk_bf16_f32 v72, v96, v97
    v_cvt_pk_bf16_f32 v73, v98, v99
    s_waitcnt lgkmcnt(2)
    v_and_b32 v52, s32, v27
    v_lshlrev_b32 v53, 16, v27
    v_and_b32 v54, s32, v26
    v_lshlrev_b32 v55, 16, v26
    v_fmac_f32 v100, v125, v52
    v_fmac_f32 v101, v125, v53
    v_fmac_f32 v102, v125, v54
    v_fmac_f32 v103, v125, v55
    v_cvt_pk_bf16_f32 v74, v100, v101
    v_cvt_pk_bf16_f32 v75, v102, v103
    s_waitcnt lgkmcnt(1)
    v_and_b32 v56, s32, v29
    v_lshlrev_b32 v57, 16, v29
    v_and_b32 v58, s32, v28
    v_lshlrev_b32 v59, 16, v28
    v_fmac_f32 v104, v125, v56
    v_fmac_f32 v105, v125, v57
    v_fmac_f32 v106, v125, v58
    v_fmac_f32 v107, v125, v59
    v_cvt_pk_bf16_f32 v76, v104, v105
    v_cvt_pk_bf16_f32 v77, v106, v107
    s_waitcnt lgkmcnt(0)
    v_and_b32 v60, s32, v31
    v_lshlrev_b32 v61, 16, v31
    v_and_b32 v62, s32, v30
    v_lshlrev_b32 v63, 16, v30
    v_fmac_f32 v108, v125, v60
    v_fmac_f32 v109, v125, v61
    v_fmac_f32 v110, v125, v62
    v_fmac_f32 v111, v125, v63
    v_cvt_pk_bf16_f32 v78, v108, v109
    v_cvt_pk_bf16_f32 v79, v110, v111
    s_cmp_eq_u32 s9, 1
    s_cbranch_scc1 PA_SP4
    buffer_store_dwordx4 v[64:67], v14, s[12:15], s33 offen offset:0 sc1
    buffer_store_dwordx4 v[68:71], v14, s[12:15], s33 offen offset:1024 sc1
    buffer_store_dwordx4 v[72:75], v14, s[12:15], s33 offen offset:2048 sc1
    buffer_store_dwordx4 v[76:79], v14, s[12:15], s33 offen offset:3072 sc1
    s_branch PA_SE4
PA_SP4:
    buffer_store_dwordx4 v[64:67], v14, s[12:15], s33 offen offset:0
    buffer_store_dwordx4 v[68:71], v14, s[12:15], s33 offen offset:1024
    buffer_store_dwordx4 v[72:75], v14, s[12:15], s33 offen offset:2048
    buffer_store_dwordx4 v[76:79], v14, s[12:15], s33 offen offset:3072
PA_SE4:
    v_mov_b32 v1, 160852
    v_mov_b32 v2, 1
    v_mov_b32 v3, s35
    s_waitcnt vmcnt(0)
    s_mov_b64 exec, 1
    ds_add_rtn_u32 v126, v1, v2
    s_mov_b32 s25, 0x4000
    s_waitcnt lgkmcnt(0)
    v_readfirstlane_b32 s24, v126
    s_cmp_lg_u32 s24, 3
    s_cbranch_scc1 PA_NOSIG2
    s_memrealtime s[92:93]
    s_waitcnt lgkmcnt(0)
    v_mov_b32 v126, s92
    v_mov_b32 v127, s93
    buffer_store_dwordx2 v[126:127], v3, s[12:15], s8 offen
    s_cmp_eq_u32 s9, 1
    s_cbranch_scc1 PA_NOSIG2
    buffer_store_dwordx2 v[126:127], v3, s[12:15], s34 offen sc1
PA_NOSIG2:
    s_mov_b64 exec, -1
    s_mov_b32 s16, s36
    s_mov_b32 s17, s37
    s_mov_b32 s18, 4194304
    s_mov_b32 s19, 0x20000
    s_mov_b32 s20, s50
    s_mov_b32 s21, s51
    s_mov_b32 s22, 8388608
    s_mov_b32 s23, 0x20000
    v_add_u32 v6, 4096, v120
    buffer_load_dwordx4 v[16:19], v120, s[16:19], 0 offen offset:0
    buffer_load_dwordx4 v[20:23], v120, s[16:19], 0 offen offset:2048
    buffer_load_dwordx4 v[24:27], v6, s[16:19], 0 offen offset:0
    buffer_load_dwordx4 v[28:31], v6, s[16:19], 0 offen offset:2048
    s_cmp_lg_u32 s24, 3
    s_cbranch_scc1 PA_LWAIT2
PA_POLL2:
    s_sleep 4
    buffer_load_dwordx2 v[126:127], v123, s[12:15], s8 offen sc1
    s_sub_u32 s25, s25, 1
    s_cbranch_scc1 PA_GOT2
    s_waitcnt vmcnt(0)
    v_cmp_lt_u64 vcc, s[96:97], v[126:127]
    v_cmp_gt_u64 s[92:93], s[94:95], v[126:127]
    s_and_b64 vcc, vcc, s[92:93]
    s_cmp_eq_u32 s9, 1
    s_cbranch_scc1 PA_PT2
    s_mov_b64 s[10:11], vcc
    buffer_load_dwordx2 v[126:127], v123, s[12:15], s34 offen sc1
    s_waitcnt vmcnt(0)
    v_cmp_lt_u64 vcc, s[96:97], v[126:127]
    v_cmp_gt_u64 s[92:93], s[94:95], v[126:127]
    s_and_b64 vcc, vcc, s[92:93]
    s_or_b64 vcc, vcc, s[10:11]
PA_PT2:
    s_cmp_lg_u64 vcc, -1
    s_cbranch_scc1 PA_POLL2
PA_GOT2:
    ds_write_b32 v1, v2 offset:4
    s_branch PA_GO2
PA_LWAIT2:
    s_sub_u32 s100, s100, 1
    s_cbranch_scc1 L_END
    s_sleep 4
    ds_read_b32 v126, v1 offset:4
    s_waitcnt lgkmcnt(0)
    v_cmp_ne_u32 vcc, 1, v126
    s_cbranch_vccnz PA_LWAIT2
PA_GO2:
    s_mov_b32 s10, 22020096
    buffer_load_dwordx2 v[32:33], v121, s[12:15], s10 offen sc1
    s_mov_b32 s10, 22024192
    buffer_load_dwordx2 v[34:35], v121, s[12:15], s10 offen sc1
    s_mov_b32 s10, 22028288
    buffer_load_dwordx2 v[36:37], v121, s[12:15], s10 offen sc1
    s_mov_b32 s10, 22032384
    buffer_load_dwordx2 v[38:39], v121, s[12:15], s10 offen sc1
    s_mov_b32 s10, 22036480
    buffer_load_dwordx2 v[40:41], v121, s[12:15], s10 offen sc1
    s_mov_b32 s10, 22040576
    buffer_load_dwordx2 v[42:43], v121, s[12:15], s10 offen sc1
    s_mov_b32 s10, 22044672
    buffer_load_dwordx2 v[44:45], v121, s[12:15], s10 offen sc1
    s_mov_b32 s10, 22048768
    buffer_load_dwordx2 v[46:47], v121, s[12:15], s10 offen sc1
    s_waitcnt vmcnt(0)
    v_lshlrev_b32 v48, 16, v16
    v_and_b32 v49, s32, v16
    v_lshlrev_b32 v50, 16, v32
    v_lshlrev_b32 v51, 16, v34
    v_pk_mul_f32 v[48:49], v[48:49], v[50:51]
    v_cvt_pk_bf16_f32 v64, v48, v49
    v_lshlrev_b32 v52, 16, v17
    v_and_b32 v53, s32, v17
    v_lshlrev_b32 v54, 16, v36
    v_lshlrev_b32 v55, 16, v38
    v_pk_mul_f32 v[52:53], v[52:53], v[54:55]
    v_cvt_pk_bf16_f32 v65, v52, v53
    v_lshlrev_b32 v48, 16, v18
    v_and_b32 v49, s32, v18
    v_lshlrev_b32 v50, 16, v40
    v_lshlrev_b32 v51, 16, v42
    v_pk_mul_f32 v[48:49], v[48:49], v[50:51]
    v_cvt_pk_bf16_f32 v66, v48, v49
    v_lshlrev_b32 v52, 16, v19
    v_and_b32 v53, s32, v19
    v_lshlrev_b32 v54, 16, v44
    v_lshlrev_b32 v55, 16, v46
    v_pk_mul_f32 v[52:53], v[52:53], v[54:55]
    v_cvt_pk_bf16_f32 v67, v52, v53
    s_mov_b32 s10, 0
    buffer_store_dwordx4 v[64:67], v122, s[20:23], s10 offen sc1
    v_lshlrev_b32 v48, 16, v20
    v_and_b32 v49, s32, v20
    v_and_b32 v50, s32, v32
    v_and_b32 v51, s32, v34
    v_pk_mul_f32 v[48:49], v[48:49], v[50:51]
    v_cvt_pk_bf16_f32 v68, v48, v49
    v_lshlrev_b32 v52, 16, v21
    v_and_b32 v53, s32, v21
    v_and_b32 v54, s32, v36
    v_and_b32 v55, s32, v38
    v_pk_mul_f32 v[52:53], v[52:53], v[54:55]
    v_cvt_pk_bf16_f32 v69, v52, v53
    v_lshlrev_b32 v48, 16, v22
    v_and_b32 v49, s32, v22
    v_and_b32 v50, s32, v40
    v_and_b32 v51, s32, v42
    v_pk_mul_f32 v[48:49], v[48:49], v[50:51]
    v_cvt_pk_bf16_f32 v70, v48, v49
    v_lshlrev_b32 v52, 16, v23
    v_and_b32 v53, s32, v23
    v_and_b32 v54, s32, v44
    v_and_b32 v55, s32, v46
    v_pk_mul_f32 v[52:53], v[52:53], v[54:55]
    v_cvt_pk_bf16_f32 v71, v52, v53
    s_mov_b32 s10, 4096
    buffer_store_dwordx4 v[68:71], v122, s[20:23], s10 offen sc1
    v_lshlrev_b32 v48, 16, v24
    v_and_b32 v49, s32, v24
    v_lshlrev_b32 v50, 16, v33
    v_lshlrev_b32 v51, 16, v35
    v_pk_mul_f32 v[48:49], v[48:49], v[50:51]
    v_cvt_pk_bf16_f32 v72, v48, v49
    v_lshlrev_b32 v52, 16, v25
    v_and_b32 v53, s32, v25
    v_lshlrev_b32 v54, 16, v37
    v_lshlrev_b32 v55, 16, v39
    v_pk_mul_f32 v[52:53], v[52:53], v[54:55]
    v_cvt_pk_bf16_f32 v73, v52, v53
    v_lshlrev_b32 v48, 16, v26
    v_and_b32 v49, s32, v26
    v_lshlrev_b32 v50, 16, v41
    v_lshlrev_b32 v51, 16, v43
    v_pk_mul_f32 v[48:49], v[48:49], v[50:51]
    v_cvt_pk_bf16_f32 v74, v48, v49
    v_lshlrev_b32 v52, 16, v27
    v_and_b32 v53, s32, v27
    v_lshlrev_b32 v54, 16, v45
    v_lshlrev_b32 v55, 16, v47
    v_pk_mul_f32 v[52:53], v[52:53], v[54:55]
    v_cvt_pk_bf16_f32 v75, v52, v53
    s_mov_b32 s10, 8192
    buffer_store_dwordx4 v[72:75], v122, s[20:23], s10 offen sc1
    v_lshlrev_b32 v48, 16, v28
    v_and_b32 v49, s32, v28
    v_and_b32 v50, s32, v33
    v_and_b32 v51, s32, v35
    v_pk_mul_f32 v[48:49], v[48:49], v[50:51]
    v_cvt_pk_bf16_f32 v76, v48, v49
    v_lshlrev_b32 v52, 16, v29
    v_and_b32 v53, s32, v29
    v_and_b32 v54, s32, v37
    v_and_b32 v55, s32, v39
    v_pk_mul_f32 v[52:53], v[52:53], v[54:55]
    v_cvt_pk_bf16_f32 v77, v52, v53
    v_lshlrev_b32 v48, 16, v30
    v_and_b32 v49, s32, v30
    v_and_b32 v50, s32, v41
    v_and_b32 v51, s32, v43
    v_pk_mul_f32 v[48:49], v[48:49], v[50:51]
    v_cvt_pk_bf16_f32 v78, v48, v49
    v_lshlrev_b32 v52, 16, v31
    v_and_b32 v53, s32, v31
    v_and_b32 v54, s32, v45
    v_and_b32 v55, s32, v47
    v_pk_mul_f32 v[52:53], v[52:53], v[54:55]
    v_cvt_pk_bf16_f32 v79, v52, v53
    s_mov_b32 s10, 12288
    buffer_store_dwordx4 v[76:79], v122, s[20:23], s10 offen sc1
    s_endpgm
L_CODE_END:
.section .rodata,"a"
.p2align 6
.amdhsa_kernel concat_heads__ssm_conv_h3__mha_block__prompt_kernel
  .amdhsa_next_free_vgpr 128
  .amdhsa_next_free_sgpr 102
  .amdhsa_accum_offset 128
  .amdhsa_group_segment_fixed_size 0
  .amdhsa_kernarg_size 96
  .amdhsa_user_sgpr_count 2
  .amdhsa_user_sgpr_kernarg_segment_ptr 1
  .amdhsa_system_sgpr_workgroup_id_x 1
.end_amdhsa_kernel
```
